```python
import torch

def _softmax(x, axis=-1):
    return torch.softmax(x, dim=axis)
def _gelu(x):
    return torch.nn.functional.gelu(x, approximate="tanh")
def _silu(x):
    return torch.nn.functional.silu(x)
def _sigmoid(x):
    return torch.sigmoid(x)
def _layernorm(x, axis=-1, eps=1e-5):
    m = x.mean(dim=axis, keepdim=True)
    v = x.var(dim=axis, keepdim=True, unbiased=False)
    return (x - m) / torch.sqrt(v + eps)
def _scatter_add(tgt, idx, src, axis=0):
    return tgt.clone().index_add_(axis, idx, src)
def _segment_sum(src, seg, n):
    out = torch.zeros((n,) + src.shape[1:], dtype=src.dtype)
    return out.index_add_(0, seg, src)
def _pad(x, pw):
    flat = tuple(v for pair in reversed(pw) for v in pair)
    return torch.nn.functional.pad(x, flat)

kernel_name = 'sequential_preLN__compressed_kv_cla__dense_activation_relu__decode'

def setup_inputs():

    _w = (lambda a: (lambda t: t.to(torch.bfloat16) if t.is_floating_point() else t)(torch.as_tensor(a)))
    def _A_setup():
        B, H, Sq, Sk, D, M = 1, 32, 1, 8192, 128, 640
        Dc = 4 * D
        return {
            "x": _w((lambda *s: torch.randn(*s, dtype=torch.bfloat16) * 0.05)(B, Sq, M)),
            "c_kv": _w((lambda *s: torch.randn(*s, dtype=torch.bfloat16) * 0.4)(B, Sk, Dc)),
            "w_q": _w((lambda *s: torch.randn(*s, dtype=torch.bfloat16) * 3.2)(M, H, D) * (M ** -0.5)),
            "w_uk": _w((lambda *s: torch.randn(*s, dtype=torch.bfloat16) * 3.2)(Dc, H, D) * (Dc ** -0.5)),
            "w_uv": _w((lambda *s: torch.randn(*s, dtype=torch.bfloat16) * 0.4)(Dc, H, D) * (Dc ** -0.5)),
            "w_o": _w((lambda *s: torch.randn(*s, dtype=torch.bfloat16) * 0.4)(H, D, M) * ((H * D) ** -0.5)),
        }
    _A_in = _A_setup()

    def _B_setup():
        B, S, D, Dff = 1, 1, 640, 1728
        return {
            "x": _w((lambda *s: torch.randn(*s, dtype=torch.bfloat16) * 0.05)(B, S, D)),
            "w1": _w((lambda *s: torch.randn(*s, dtype=torch.bfloat16) * 0.05)(D, Dff)),
            "w2": _w((lambda *s: torch.randn(*s, dtype=torch.bfloat16) * 0.05)(Dff, D)),
        }
    _B_in = _B_setup()

    return {
        "A_x": _A_in["x"],
        "A_c_kv": _A_in["c_kv"],
        "A_w_q": _A_in["w_q"],
        "A_w_uk": _A_in["w_uk"],
        "A_w_uv": _A_in["w_uv"],
        "A_w_o": _A_in["w_o"],
        "B_x": _B_in["x"],
        "B_w1": _B_in["w1"],
        "B_w2": _B_in["w2"],
    }

def reference(A_x, A_c_kv, A_w_q, A_w_uk, A_w_uv, A_w_o, B_x, B_w1, B_w2):
    def _A_ref(x, c_kv, w_q, w_uk, w_uv, w_o):
        B, Sq, M = x.shape[0], x.shape[1], x.shape[2]
        Sk = c_kv.shape[1]
        H, D = w_q.shape[1], w_q.shape[2]
        q = torch.einsum("bqm,mhd->bhqd", x, w_q)
        k = torch.einsum("bkc,chd->bhkd", c_kv, w_uk)
        v = torch.einsum("bkc,chd->bhkd", c_kv, w_uv)
        scores = torch.einsum("bhqd,bhkd->bhqk", q, k) * (D ** -0.5)
        off = Sk - Sq
        qi = torch.arange(Sq)[:, None]
        kj = torch.arange(Sk)[None, :]
        cmask = kj <= (qi + off)
        scores = torch.where(cmask[None, None], scores, -1e9)
        p = _softmax(scores, axis=-1)
        ctx = torch.einsum("bhqk,bhkd->bhqd", p, v)
        return torch.einsum("bhqd,hdm->bqm", ctx, w_o)

    def _B_ref(x, w1, w2):
        h = torch.einsum("bsd,df->bsf", x, w1)
        zero = torch.zeros_like(h)
        h = torch.maximum(h, zero)
        return torch.einsum("bsf,fd->bsd", h, w2)

    x = A_x
    h = x + _A_ref(_layernorm(x, axis=-1), A_c_kv, A_w_q, A_w_uk, A_w_uv, A_w_o)
    h2 = h + _B_ref(_layernorm(h, axis=-1), B_w1, B_w2)
    return h2
```

```asm
; @launch grid=(256,1,1) block=(512,1,1) lds=162048
.amdgcn_target "amdgcn-amd-amdhsa--gfx950"
.text
.globl sequential_preLN__compressed_kv_cla__dense_activation_relu__decode_kernel
.p2align 8
.type sequential_preLN__compressed_kv_cla__dense_activation_relu__decode_kernel,@function
sequential_preLN__compressed_kv_cla__dense_activation_relu__decode_kernel:
    s_cmp_ge_u32 s2, 256
    s_cbranch_scc1 L_end
    s_load_dwordx16 s[64:79], s[0:1], 0
    s_add_u32 s2, s2, 248
    s_and_b32 s2, s2, 255
    s_load_dwordx8 s[80:87], s[0:1], 64
    s_getpc_b64 s[92:93]
L_pcref0:
    s_sub_u32 s92, s92, (L_pcref0 - sequential_preLN__compressed_kv_cla__dense_activation_relu__decode_kernel)
    s_subb_u32 s93, s93, 0
    s_bfe_u32 s94, s2, 0x10003
    s_lshl_b32 s94, s94, 13
    v_lshlrev_b32 v4, 4, v0
    v_add_u32 v4, s94, v4
    v_min_u32 v4, ((L_end - sequential_preLN__compressed_kv_cla__dense_activation_relu__decode_kernel - 16) & 0xfffffff0), v4
    global_load_dwordx4 v[232:235], v4, s[92:93]
    v_and_b32 v1, 63, v0
    v_lshrrev_b32 v4, 6, v0
    v_and_b32 v2, 15, v0
    v_bfe_u32 v3, v0, 4, 2
    v_readfirstlane_b32 s48, v4
    v_mov_b32 v44, -1
    v_mov_b32 v45, -1
    v_mov_b32 v46, -1
    v_mov_b32 v47, -1
    v_lshlrev_b32 v41, 4, v1
    s_bfe_u32 s49, s2, 0x40003
    s_and_b32 s50, s2, 7
    s_mov_b32 s94, 0x3fb8aa3b
    s_mov_b32 s46, 9437184
    s_mov_b32 s47, 0x00020000
    s_mov_b32 s6, 1280
    s_mov_b32 s7, 0x00020000
    s_mov_b32 s14, 5242880
    s_mov_b32 s15, 0x00020000
    s_mov_b32 s10, 8388608
    s_mov_b32 s11, 0x00020000
    s_mov_b32 s18, 4194304
    s_mov_b32 s19, 0x00020000
    s_mov_b32 s42, 256
    s_mov_b32 s43, 0x00020000
    s_mov_b32 s22, 4194304
    s_mov_b32 s23, 0x00020000
    s_mov_b32 s26, 5242880
    s_mov_b32 s27, 0x00020000
    s_mov_b32 s30, 2211840
    s_mov_b32 s31, 0x00020000
    s_mov_b32 s34, 2211840
    s_mov_b32 s35, 0x00020000
    s_mov_b32 s38, 1280
    s_mov_b32 s39, 0x00020000
    s_cmp_ge_u32 s2, 128
    s_cbranch_scc1 L_Y
    s_lshl_b32 s56, s50, 2
    s_lshr_b32 s52, s49, 2
    s_add_u32 s56, s56, s52
    s_and_b32 s57, s49, 3
    s_lshl_b32 s58, s56, 2
    s_add_u32 s58, s58, s57
    s_mul_i32 s99, s2, 205
    s_lshr_b32 s99, s99, 11
    s_mul_i32 s52, s99, 10
    s_sub_u32 s98, s2, s52
    s_mul_i32 s100, s99, 11
    s_max_u32 s52, s99, 8
    s_sub_u32 s52, s52, 8
    s_sub_u32 s100, s100, s52
    s_cmp_lt_u32 s99, 8
    s_cselect_b32 s101, 11, 10
    v_mov_b32 v128, 0
    v_mov_b32 v129, 0
    v_mov_b32 v130, 0
    v_mov_b32 v131, 0
    v_mov_b32 v132, 0
    v_mov_b32 v133, 0
    v_mov_b32 v134, 0
    v_mov_b32 v135, 0
    v_mov_b32 v136, 0
    v_mov_b32 v137, 0
    v_mov_b32 v138, 0
    v_mov_b32 v139, 0
    v_mov_b32 v140, 0
    v_mov_b32 v141, 0
    v_mov_b32 v142, 0
    v_mov_b32 v143, 0
    v_lshlrev_b32 v192, 4, v2
    v_lshl_add_u32 v192, v3, 2, v192
    v_mul_u32_u24 v193, 272, v2
    v_lshl_add_u32 v193, v3, 4, v193
    v_add_u32 v193, 4096, v193
    v_lshlrev_b32 v194, 1, v2
    v_lshlrev_b32 v4, 2, v1
    v_lshlrev_b32 v5, 1, v1
    s_mul_i32 s52, s57, 160
    s_mul_i32 s53, s48, 40
    s_add_u32 s52, s52, s53
    s_lshl_b32 s53, s52, 1
    v_lshlrev_b32 v6, 13, v3
    v_lshl_add_u32 v6, v2, 4, v6
    s_lshl_b32 s52, s52, 13
    s_lshl_b32 s54, s56, 8
    s_add_u32 s52, s52, s54
    s_waitcnt lgkmcnt(0)
    s_mov_b64 s[44:45], s[86:87]
    s_mov_b64 s[4:5], s[64:65]
    s_mov_b64 s[12:13], s[68:69]
    s_mov_b64 s[8:9], s[66:67]
    s_mov_b64 s[16:17], s[70:71]
    s_mov_b64 s[40:41], s[84:85]
    s_mov_b64 s[20:21], s[72:73]
    s_mov_b64 s[24:25], s[74:75]
    s_mov_b64 s[28:29], s[78:79]
    s_mov_b64 s[32:33], s[80:81]
    s_mov_b64 s[36:37], s[82:83]
    s_cmp_ge_u32 s48, 4
    s_cbranch_scc1 L_S_2
    buffer_load_dword v186, v4, s[4:7], 0 offen offset:0
    buffer_load_dword v187, v4, s[4:7], 0 offen offset:256
    buffer_load_dword v188, v4, s[4:7], 0 offen offset:512
    buffer_load_dword v189, v4, s[4:7], 0 offen offset:768
    buffer_load_dword v190, v4, s[4:7], 0 offen offset:1024
    buffer_load_ushort v191, v5, s[4:7], s53 offen
    s_barrier
    buffer_load_dwordx4 v[48:51], v6, s[12:15], s52 offen nt
    s_add_u32 s52, s52, 32768
    buffer_load_dwordx4 v[52:55], v6, s[12:15], s52 offen nt
    s_add_u32 s52, s52, 32768
    buffer_load_dwordx4 v[56:59], v6, s[12:15], s52 offen nt
    s_add_u32 s52, s52, 32768
    buffer_load_dwordx4 v[60:63], v6, s[12:15], s52 offen nt
    s_add_u32 s52, s52, 32768
    buffer_load_dwordx4 v[64:67], v6, s[12:15], s52 offen nt
    s_add_u32 s52, s52, 32768
    buffer_load_dwordx4 v[68:71], v6, s[12:15], s52 offen nt
    s_add_u32 s52, s52, 32768
    buffer_load_dwordx4 v[72:75], v6, s[12:15], s52 offen nt
    s_add_u32 s52, s52, 32768
    buffer_load_dwordx4 v[76:79], v6, s[12:15], s52 offen nt
    s_add_u32 s52, s52, 32768
    buffer_load_dwordx4 v[80:83], v6, s[12:15], s52 offen nt
    s_add_u32 s52, s52, 32768
    buffer_load_dwordx4 v[84:87], v6, s[12:15], s52 offen nt
    s_barrier
    s_waitcnt vmcnt(10)
    v_readfirstlane_b32 s52, v186
    v_lshlrev_b32 v8, 16, v186
    v_and_b32 v9, 0xffff0000, v186
    v_lshlrev_b32 v10, 16, v187
    v_and_b32 v11, 0xffff0000, v187
    v_lshlrev_b32 v12, 16, v188
    v_and_b32 v13, 0xffff0000, v188
    v_lshlrev_b32 v14, 16, v189
    v_and_b32 v15, 0xffff0000, v189
    v_lshlrev_b32 v16, 16, v190
    v_and_b32 v17, 0xffff0000, v190
    s_lshl_b32 s52, s52, 16
    s_mov_b32 s53, s52
    v_pk_add_f32 v[8:9], v[8:9], s[52:53] neg_lo:[0,1] neg_hi:[0,1]
    v_pk_add_f32 v[10:11], v[10:11], s[52:53] neg_lo:[0,1] neg_hi:[0,1]
    v_pk_add_f32 v[12:13], v[12:13], s[52:53] neg_lo:[0,1] neg_hi:[0,1]
    v_pk_add_f32 v[14:15], v[14:15], s[52:53] neg_lo:[0,1] neg_hi:[0,1]
    v_pk_add_f32 v[16:17], v[16:17], s[52:53] neg_lo:[0,1] neg_hi:[0,1]
    v_pk_add_f32 v[22:23], v[8:9], v[10:11]
    v_pk_mul_f32 v[24:25], v[8:9], v[8:9]
    v_pk_fma_f32 v[24:25], v[10:11], v[10:11], v[24:25]
    v_pk_add_f32 v[22:23], v[22:23], v[12:13]
    v_pk_fma_f32 v[24:25], v[12:13], v[12:13], v[24:25]
    v_pk_add_f32 v[22:23], v[22:23], v[14:15]
    v_pk_fma_f32 v[24:25], v[14:15], v[14:15], v[24:25]
    v_pk_add_f32 v[22:23], v[22:23], v[16:17]
    v_pk_fma_f32 v[24:25], v[16:17], v[16:17], v[24:25]
    v_add_f32 v18, v22, v23
    v_add_f32 v19, v24, v25
    s_nop 0
    v_add_f32_dpp v18, v18, v18 row_shr:1 row_mask:0xf bank_mask:0xf bound_ctrl:0
    v_add_f32_dpp v19, v19, v19 row_shr:1 row_mask:0xf bank_mask:0xf bound_ctrl:0
    s_nop 0
    v_add_f32_dpp v18, v18, v18 row_shr:2 row_mask:0xf bank_mask:0xf bound_ctrl:0
    v_add_f32_dpp v19, v19, v19 row_shr:2 row_mask:0xf bank_mask:0xf bound_ctrl:0
    s_nop 0
    v_add_f32_dpp v18, v18, v18 row_shr:4 row_mask:0xf bank_mask:0xf bound_ctrl:0
    v_add_f32_dpp v19, v19, v19 row_shr:4 row_mask:0xf bank_mask:0xf bound_ctrl:0
    s_nop 0
    v_add_f32_dpp v18, v18, v18 row_shr:8 row_mask:0xf bank_mask:0xf bound_ctrl:0
    v_add_f32_dpp v19, v19, v19 row_shr:8 row_mask:0xf bank_mask:0xf bound_ctrl:0
    s_nop 0
    v_add_f32_dpp v18, v18, v18 row_bcast:15 row_mask:0xa bank_mask:0xf
    v_add_f32_dpp v19, v19, v19 row_bcast:15 row_mask:0xa bank_mask:0xf
    s_nop 0
    v_add_f32_dpp v18, v18, v18 row_bcast:31 row_mask:0xc bank_mask:0xf
    v_add_f32_dpp v19, v19, v19 row_bcast:31 row_mask:0xc bank_mask:0xf
    v_readlane_b32 s54, v18, 63
    v_readlane_b32 s55, v19, 63
    s_mov_b32 s53, 0x3acccccd
    v_mov_b32 v20, s54
    v_mov_b32 v21, s55
    v_mul_f32 v20, s53, v20
    v_mul_f32 v21, s53, v21
    v_fma_f32 v21, -v20, v20, v21
    v_max_f32 v21, 0, v21
    v_add_f32 v20, s52, v20
    v_cvt_pk_bf16_f32 v20, v20, v20
    v_lshlrev_b32 v20, 16, v20
    v_cvt_pk_bf16_f32 v21, v21, v21
    v_lshlrev_b32 v21, 16, v21
    v_add_f32 v21, 0x3727c5ac, v21
    v_cvt_pk_bf16_f32 v21, v21, v21
    v_lshlrev_b32 v21, 16, v21
    v_sqrt_f32 v21, v21
    s_nop 0
    v_cvt_pk_bf16_f32 v21, v21, v21
    v_lshlrev_b32 v21, 16, v21
    v_rcp_f32 v22, v21
    v_lshlrev_b32 v191, 16, v191
    v_sub_f32 v191, v191, v20
    v_cvt_pk_bf16_f32 v191, v191, v191
    v_lshlrev_b32 v191, 16, v191
    v_mul_f32 v19, v191, v22
    v_fma_f32 v18, -v19, v21, v191
    v_fmac_f32 v19, v18, v22
    v_cvt_pk_bf16_f32 v191, v19, v19
    v_lshlrev_b32 v191, 16, v191
    v_and_b32 v4, 3, v1
    v_lshlrev_b32 v4, 6, v4
    v_and_b32 v5, 0x3c, v1
    v_add_u32 v4, v4, v5
    s_lshl_b32 s52, s48, 8
    v_add_u32 v4, s52, v4
    ds_write_b32 v4, v191 offset:8448
    v_lshlrev_b32 v5, 6, v3
    v_add_u32 v5, s52, v5
    s_waitcnt lgkmcnt(0)
    ds_read_b128 v[164:167], v5 offset:8448
    ds_read_b128 v[168:171], v5 offset:8464
    ds_read_b128 v[172:175], v5 offset:8480
    s_lshl_b32 s83, s50, 5
    v_mov_b32 v28, 0
    s_cmp_lg_u32 s48, 0
    s_cbranch_scc1 L_f0_3
    s_mov_b32 exec_lo, 0x1
    s_mov_b32 exec_hi, 0x0
    buffer_load_dword v42, v28, s[40:43], s83 offen sc1
    s_mov_b64 exec, -1
L_f0_3:
    v_lshlrev_b32 v5, 1, v192
    s_lshl_b32 s52, s48, 9
    v_add_u32 v5, s52, v5
    s_mul_i32 s52, s48, 544
    s_add_u32 s52, s52, 4096
    v_add_u32 v192, s52, v192
    v_lshlrev_b32 v6, 3, v1
    v_lshlrev_b32 v37, 2, v1
    s_lshl_b32 s52, s48, 13
    s_add_u32 s52, s52, 90112
    v_xor_b32 v4, v2, v3
    v_xor_b32 v196, 0, v4
    v_lshlrev_b32 v196, 4, v196
    v_lshl_add_u32 v196, v2, 8, v196
    v_add_u32 v196, s52, v196
    v_xor_b32 v197, 4, v4
    v_lshlrev_b32 v197, 4, v197
    v_lshl_add_u32 v197, v2, 8, v197
    v_add_u32 v197, s52, v197
    v_xor_b32 v198, 8, v4
    v_lshlrev_b32 v198, 4, v198
    v_lshl_add_u32 v198, v2, 8, v198
    v_add_u32 v198, s52, v198
    v_xor_b32 v199, 12, v4
    v_lshlrev_b32 v199, 4, v199
    v_lshl_add_u32 v199, v2, 8, v199
    v_add_u32 v199, s52, v199
    v_lshlrev_b32 v4, 8, v2
    v_lshl_add_u32 v4, v3, 4, v4
    v_mov_b32 v8, 0
    v_mov_b32 v9, 0
    v_mov_b32 v10, 0
    v_mov_b32 v11, 0
    v_mov_b32 v12, 0
    v_mov_b32 v13, 0
    v_mov_b32 v14, 0
    v_mov_b32 v15, 0
    s_mov_b32 s90, 0x00ff00ff
    s_mov_b32 s91, 0x00ff00ff
    s_lshl_b32 s54, s58, 9
    s_add_u32 s54, s54, 73728
    s_lshl_b32 s55, s56, 11
    s_add_u32 s55, s55, 73728
    s_waitcnt lgkmcnt(0)
    v_lshrrev_b32 v176, 16, v164
    v_lshrrev_b32 v177, 16, v165
    v_lshrrev_b32 v178, 16, v166
    v_lshrrev_b32 v179, 16, v167
    v_lshrrev_b32 v180, 16, v168
    v_lshrrev_b32 v181, 16, v169
    v_lshrrev_b32 v182, 16, v170
    v_lshrrev_b32 v183, 16, v171
    v_lshrrev_b32 v184, 16, v172
    v_lshrrev_b32 v185, 16, v173
    s_cmp_eq_u32 s48, 0
    s_cbranch_scc1 L_a1_4
    s_waitcnt vmcnt(9)
    v_dot2c_f32_bf16 v8, v48, v176
    v_dot2c_f32_bf16 v9, v48, v164
    v_dot2c_f32_bf16 v10, v49, v176
    v_dot2c_f32_bf16 v11, v49, v164
    v_dot2c_f32_bf16 v12, v50, v176
    v_dot2c_f32_bf16 v13, v50, v164
    v_dot2c_f32_bf16 v14, v51, v176
    v_dot2c_f32_bf16 v15, v51, v164
    s_waitcnt vmcnt(8)
    v_dot2c_f32_bf16 v8, v52, v177
    v_dot2c_f32_bf16 v9, v52, v165
    v_dot2c_f32_bf16 v10, v53, v177
    v_dot2c_f32_bf16 v11, v53, v165
    v_dot2c_f32_bf16 v12, v54, v177
    v_dot2c_f32_bf16 v13, v54, v165
    v_dot2c_f32_bf16 v14, v55, v177
    v_dot2c_f32_bf16 v15, v55, v165
    s_waitcnt vmcnt(7)
    v_dot2c_f32_bf16 v8, v56, v178
    v_dot2c_f32_bf16 v9, v56, v166
    v_dot2c_f32_bf16 v10, v57, v178
    v_dot2c_f32_bf16 v11, v57, v166
    v_dot2c_f32_bf16 v12, v58, v178
    v_dot2c_f32_bf16 v13, v58, v166
    v_dot2c_f32_bf16 v14, v59, v178
    v_dot2c_f32_bf16 v15, v59, v166
    s_waitcnt vmcnt(6)
    v_dot2c_f32_bf16 v8, v60, v179
    v_dot2c_f32_bf16 v9, v60, v167
    v_dot2c_f32_bf16 v10, v61, v179
    v_dot2c_f32_bf16 v11, v61, v167
    v_dot2c_f32_bf16 v12, v62, v179
    v_dot2c_f32_bf16 v13, v62, v167
    v_dot2c_f32_bf16 v14, v63, v179
    v_dot2c_f32_bf16 v15, v63, v167
    s_waitcnt vmcnt(5)
    v_dot2c_f32_bf16 v8, v64, v180
    v_dot2c_f32_bf16 v9, v64, v168
    v_dot2c_f32_bf16 v10, v65, v180
    v_dot2c_f32_bf16 v11, v65, v168
    v_dot2c_f32_bf16 v12, v66, v180
    v_dot2c_f32_bf16 v13, v66, v168
    v_dot2c_f32_bf16 v14, v67, v180
    v_dot2c_f32_bf16 v15, v67, v168
    s_waitcnt vmcnt(4)
    v_dot2c_f32_bf16 v8, v68, v181
    v_dot2c_f32_bf16 v9, v68, v169
    v_dot2c_f32_bf16 v10, v69, v181
    v_dot2c_f32_bf16 v11, v69, v169
    v_dot2c_f32_bf16 v12, v70, v181
    v_dot2c_f32_bf16 v13, v70, v169
    v_dot2c_f32_bf16 v14, v71, v181
    v_dot2c_f32_bf16 v15, v71, v169
    s_waitcnt vmcnt(3)
    v_dot2c_f32_bf16 v8, v72, v182
    v_dot2c_f32_bf16 v9, v72, v170
    v_dot2c_f32_bf16 v10, v73, v182
    v_dot2c_f32_bf16 v11, v73, v170
    v_dot2c_f32_bf16 v12, v74, v182
    v_dot2c_f32_bf16 v13, v74, v170
    v_dot2c_f32_bf16 v14, v75, v182
    v_dot2c_f32_bf16 v15, v75, v170
    s_waitcnt vmcnt(2)
    v_dot2c_f32_bf16 v8, v76, v183
    v_dot2c_f32_bf16 v9, v76, v171
    v_dot2c_f32_bf16 v10, v77, v183
    v_dot2c_f32_bf16 v11, v77, v171
    v_dot2c_f32_bf16 v12, v78, v183
    v_dot2c_f32_bf16 v13, v78, v171
    v_dot2c_f32_bf16 v14, v79, v183
    v_dot2c_f32_bf16 v15, v79, v171
    s_waitcnt vmcnt(1)
    v_dot2c_f32_bf16 v8, v80, v184
    v_dot2c_f32_bf16 v9, v80, v172
    v_dot2c_f32_bf16 v10, v81, v184
    v_dot2c_f32_bf16 v11, v81, v172
    v_dot2c_f32_bf16 v12, v82, v184
    v_dot2c_f32_bf16 v13, v82, v172
    v_dot2c_f32_bf16 v14, v83, v184
    v_dot2c_f32_bf16 v15, v83, v172
    s_waitcnt vmcnt(0)
    v_dot2c_f32_bf16 v8, v84, v185
    v_dot2c_f32_bf16 v9, v84, v173
    v_dot2c_f32_bf16 v10, v85, v185
    v_dot2c_f32_bf16 v11, v85, v173
    v_dot2c_f32_bf16 v12, v86, v185
    v_dot2c_f32_bf16 v13, v86, v173
    v_dot2c_f32_bf16 v14, v87, v185
    v_dot2c_f32_bf16 v15, v87, v173
    s_nop 3
    s_branch L_a1_5
L_a1_4:
    s_waitcnt vmcnt(10)
    v_dot2c_f32_bf16 v8, v48, v176
    v_dot2c_f32_bf16 v9, v48, v164
    v_dot2c_f32_bf16 v10, v49, v176
    v_dot2c_f32_bf16 v11, v49, v164
    v_dot2c_f32_bf16 v12, v50, v176
    v_dot2c_f32_bf16 v13, v50, v164
    v_dot2c_f32_bf16 v14, v51, v176
    v_dot2c_f32_bf16 v15, v51, v164
    s_waitcnt vmcnt(9)
    v_dot2c_f32_bf16 v8, v52, v177
    v_dot2c_f32_bf16 v9, v52, v165
    v_dot2c_f32_bf16 v10, v53, v177
    v_dot2c_f32_bf16 v11, v53, v165
    v_dot2c_f32_bf16 v12, v54, v177
    v_dot2c_f32_bf16 v13, v54, v165
    v_dot2c_f32_bf16 v14, v55, v177
    v_dot2c_f32_bf16 v15, v55, v165
    s_waitcnt vmcnt(8)
    v_dot2c_f32_bf16 v8, v56, v178
    v_dot2c_f32_bf16 v9, v56, v166
    v_dot2c_f32_bf16 v10, v57, v178
    v_dot2c_f32_bf16 v11, v57, v166
    v_dot2c_f32_bf16 v12, v58, v178
    v_dot2c_f32_bf16 v13, v58, v166
    v_dot2c_f32_bf16 v14, v59, v178
    v_dot2c_f32_bf16 v15, v59, v166
    s_waitcnt vmcnt(7)
    v_dot2c_f32_bf16 v8, v60, v179
    v_dot2c_f32_bf16 v9, v60, v167
    v_dot2c_f32_bf16 v10, v61, v179
    v_dot2c_f32_bf16 v11, v61, v167
    v_dot2c_f32_bf16 v12, v62, v179
    v_dot2c_f32_bf16 v13, v62, v167
    v_dot2c_f32_bf16 v14, v63, v179
    v_dot2c_f32_bf16 v15, v63, v167
    s_waitcnt vmcnt(6)
    v_dot2c_f32_bf16 v8, v64, v180
    v_dot2c_f32_bf16 v9, v64, v168
    v_dot2c_f32_bf16 v10, v65, v180
    v_dot2c_f32_bf16 v11, v65, v168
    v_dot2c_f32_bf16 v12, v66, v180
    v_dot2c_f32_bf16 v13, v66, v168
    v_dot2c_f32_bf16 v14, v67, v180
    v_dot2c_f32_bf16 v15, v67, v168
    s_waitcnt vmcnt(5)
    v_dot2c_f32_bf16 v8, v68, v181
    v_dot2c_f32_bf16 v9, v68, v169
    v_dot2c_f32_bf16 v10, v69, v181
    v_dot2c_f32_bf16 v11, v69, v169
    v_dot2c_f32_bf16 v12, v70, v181
    v_dot2c_f32_bf16 v13, v70, v169
    v_dot2c_f32_bf16 v14, v71, v181
    v_dot2c_f32_bf16 v15, v71, v169
    s_waitcnt vmcnt(4)
    v_dot2c_f32_bf16 v8, v72, v182
    v_dot2c_f32_bf16 v9, v72, v170
    v_dot2c_f32_bf16 v10, v73, v182
    v_dot2c_f32_bf16 v11, v73, v170
    v_dot2c_f32_bf16 v12, v74, v182
    v_dot2c_f32_bf16 v13, v74, v170
    v_dot2c_f32_bf16 v14, v75, v182
    v_dot2c_f32_bf16 v15, v75, v170
    s_waitcnt vmcnt(3)
    v_dot2c_f32_bf16 v8, v76, v183
    v_dot2c_f32_bf16 v9, v76, v171
    v_dot2c_f32_bf16 v10, v77, v183
    v_dot2c_f32_bf16 v11, v77, v171
    v_dot2c_f32_bf16 v12, v78, v183
    v_dot2c_f32_bf16 v13, v78, v171
    v_dot2c_f32_bf16 v14, v79, v183
    v_dot2c_f32_bf16 v15, v79, v171
    s_waitcnt vmcnt(2)
    v_dot2c_f32_bf16 v8, v80, v184
    v_dot2c_f32_bf16 v9, v80, v172
    v_dot2c_f32_bf16 v10, v81, v184
    v_dot2c_f32_bf16 v11, v81, v172
    v_dot2c_f32_bf16 v12, v82, v184
    v_dot2c_f32_bf16 v13, v82, v172
    v_dot2c_f32_bf16 v14, v83, v184
    v_dot2c_f32_bf16 v15, v83, v172
    s_waitcnt vmcnt(1)
    v_dot2c_f32_bf16 v8, v84, v185
    v_dot2c_f32_bf16 v9, v84, v173
    v_dot2c_f32_bf16 v10, v85, v185
    v_dot2c_f32_bf16 v11, v85, v173
    v_dot2c_f32_bf16 v12, v86, v185
    v_dot2c_f32_bf16 v13, v86, v173
    v_dot2c_f32_bf16 v14, v87, v185
    v_dot2c_f32_bf16 v15, v87, v173
    s_nop 3
L_a1_5:
    v_permlane32_swap_b32 v8, v12
    v_permlane32_swap_b32 v9, v13
    v_permlane32_swap_b32 v10, v14
    v_permlane32_swap_b32 v11, v15
    v_add_f32 v8, v8, v12
    v_add_f32 v9, v9, v13
    v_add_f32 v10, v10, v14
    v_add_f32 v11, v11, v15
    s_nop 0
    v_permlane16_swap_b32 v8, v10
    v_permlane16_swap_b32 v9, v11
    v_add_f32 v8, v8, v10
    v_add_f32 v9, v9, v11
    ds_write_b64 v5, v[8:9] offset:0
    s_mov_b32 s51, 0
    s_cmp_lg_u32 s48, 0
    s_cbranch_scc1 L_fo_6
    s_mov_b32 exec_lo, 0x1
    s_mov_b32 exec_hi, 0x0
    s_branch L_f1_8
L_fp_7:
    s_mov_b32 exec_lo, 0x1
    s_mov_b32 exec_hi, 0x0
    buffer_load_dword v42, v28, s[40:43], s83 offen sc1
L_f1_8:
    s_waitcnt vmcnt(0)
    v_cmp_eq_u32 vcc, 0, v42
    s_mov_b64 exec, -1
    s_cbranch_vccz L_fo_6
    s_add_u32 s51, s51, 1
    s_cmp_gt_u32 s51, 200000
    s_cbranch_scc1 L_fo_6
    s_sleep 2
    s_branch L_fp_7
L_fo_6:
    s_waitcnt lgkmcnt(0)
    s_barrier
    s_cmp_lg_u32 s48, 0
    s_cbranch_scc1 L_a1w_9
    ds_read_b64 v[96:97], v6 offset:0
    ds_read_b64 v[98:99], v6 offset:512
    ds_read_b64 v[100:101], v6 offset:1024
    ds_read_b64 v[102:103], v6 offset:1536
L_a1w_9:
    s_cmp_lg_u32 s48, 0
    s_cbranch_scc1 L_a1w_10
    s_waitcnt lgkmcnt(0)
    v_pk_add_f32 v[96:97], v[96:97], v[98:99]
    v_pk_add_f32 v[100:101], v[100:101], v[102:103]
    v_pk_add_f32 v[96:97], v[96:97], v[100:101]
    v_min_u32 v96, -2, v96
    v_min_u32 v97, -2, v97
    buffer_store_dwordx2 v[96:97], v6, s[44:47], s54 offen sc1
L_a1w_10:
    s_sleep 4
    s_lshl_b32 s52, s48, 8
    v_add_u32 v36, s52, v37
    v_lshlrev_b32 v4, 4, v3
    v_add_u32 v4, s52, v4
    s_mov_b64 s[60:61], -1
    s_mov_b64 s[62:63], -1
    s_mov_b32 s51, 0
L_poll_11:
    s_mov_b64 exec, s[60:61]
    buffer_load_dwordx2 v[100:101], v6, s[44:47], s55 offen offset:0 sc1
    buffer_load_dwordx2 v[102:103], v6, s[44:47], s55 offen offset:512 sc1
    s_mov_b64 exec, s[62:63]
    buffer_load_dwordx2 v[104:105], v6, s[44:47], s55 offen offset:1024 sc1
    buffer_load_dwordx2 v[106:107], v6, s[44:47], s55 offen offset:1536 sc1
    s_mov_b64 exec, -1
    s_waitcnt vmcnt(0)
    v_max_u32 v39, v100, v101
    v_max3_u32 v39, v39, v102, v103
    v_cmp_eq_u32 s[76:77], -1, v39
    s_and_b64 s[60:61], s[60:61], s[76:77]
    v_max_u32 v39, v104, v105
    v_max3_u32 v39, v39, v106, v107
    v_cmp_eq_u32 s[76:77], -1, v39
    s_and_b64 s[62:63], s[62:63], s[76:77]
    s_or_b64 s[78:79], s[60:61], s[62:63]
    s_cbranch_scc0 L_polld_12
    s_add_u32 s51, s51, 1
    s_cmp_gt_u32 s51, 200000
    s_cbranch_scc1 L_polld_12
    s_sleep 1
    s_branch L_poll_11
L_polld_12:
    v_pk_add_f32 v[8:9], v[100:101], v[102:103]
    v_pk_add_f32 v[10:11], v[104:105], v[106:107]
    v_pk_add_f32 v[8:9], v[8:9], v[10:11]
    v_cvt_pk_bf16_f32 v8, v8, v9
    ds_write_b32 v36, v8 offset:8448
    s_waitcnt lgkmcnt(0)
    ds_read_b128 v[204:207], v4 offset:8448
    ds_read_b128 v[208:211], v4 offset:8512
    ds_read_b128 v[212:215], v4 offset:8576
    ds_read_b128 v[216:219], v4 offset:8640
    s_cmp_lg_u32 s48, 1
    s_cbranch_scc1 L_ew_13
    s_lshl_b32 s52, s58, 6
    s_add_u32 s52, s52, 65536
    v_mov_b32 v7, 1
    v_mov_b32 v38, 0
    s_mov_b32 exec_lo, 0x1
    s_mov_b32 exec_hi, 0x0
    buffer_store_dword v7, v38, s[44:47], s52 offen sc1
    s_mov_b64 exec, -1
L_ew_13:
    s_barrier
    ds_read_b128 v[48:51], v196 offset:0
    ds_read_b128 v[52:55], v197 offset:0
    ds_read_b128 v[56:59], v198 offset:0
    ds_read_b128 v[60:63], v199 offset:0
    ds_read_b128 v[64:67], v196 offset:4096
    ds_read_b128 v[68:71], v197 offset:4096
    ds_read_b128 v[72:75], v198 offset:4096
    ds_read_b128 v[76:79], v199 offset:4096
    s_lshl_b32 s52, s58, 8
    s_lshl_b32 s53, s48, 6
    s_add_u32 s52, s52, s53
    v_lshlrev_b32 v5, 1, v1
    s_waitcnt lgkmcnt(7)
    v_mfma_f32_16x16x32_bf16 v[8:11], v[204:207], v[48:51], 0
    s_waitcnt lgkmcnt(6)
    v_mfma_f32_16x16x32_bf16 v[8:11], v[208:211], v[52:55], v[8:11]
    s_waitcnt lgkmcnt(5)
    v_mfma_f32_16x16x32_bf16 v[8:11], v[212:215], v[56:59], v[8:11]
    s_waitcnt lgkmcnt(4)
    v_mfma_f32_16x16x32_bf16 v[8:11], v[216:219], v[60:63], v[8:11]
    s_waitcnt lgkmcnt(3)
    v_mfma_f32_16x16x32_bf16 v[12:15], v[204:207], v[64:67], 0
    s_waitcnt lgkmcnt(2)
    v_mfma_f32_16x16x32_bf16 v[12:15], v[208:211], v[68:71], v[12:15]
    s_waitcnt lgkmcnt(1)
    v_mfma_f32_16x16x32_bf16 v[12:15], v[212:215], v[72:75], v[12:15]
    s_waitcnt lgkmcnt(0)
    v_mfma_f32_16x16x32_bf16 v[12:15], v[216:219], v[76:79], v[12:15]
    s_nop 7
    v_mov_b32_dpp v8, v12 quad_perm:[0,1,2,3] row_mask:0x2 bank_mask:0xf
    s_nop 1
    v_mov_b32_dpp v9, v8 row_shl:1 row_mask:0xf bank_mask:0xf bound_ctrl:0
    v_cvt_pk_bf16_f32 v8, v8, v9
    v_min_u32 v8, -2, v8
    s_mov_b32 exec_lo, 0x55555555
    s_mov_b32 exec_hi, 0x0
    buffer_store_dword v8, v5, s[44:47], s52 offen sc1
    s_mov_b64 exec, -1
    s_barrier
    s_lshr_b32 s52, s56, 4
    s_lshl_b32 s52, s52, 7
    s_and_b32 s53, s56, 15
    s_lshl_b32 s53, s53, 3
    s_add_u32 s52, s52, s53
    s_add_u32 s52, s52, 147456
    s_lshl_b32 s53, s48, 12
    s_add_u32 s53, s53, s52
    v_lshlrev_b32 v5, 8, v1
    v_lshlrev_b32 v6, 15, v3
    v_lshl_add_u32 v6, v2, 4, v6
    s_lshl_b32 s54, s48, 19
    s_lshl_b32 s55, s58, 8
    s_add_u32 s54, s54, s55
    s_add_u32 s54, s54, 1048576
    s_add_u32 s55, s54, 0x20000
    s_add_u32 s95, s54, 0x40000
    s_add_u32 s80, s54, 0x60000
    s_lshl_b32 s81, s48, 6
    v_lshlrev_b32 v4, 2, v3
    v_add_u32 v4, s81, v4
    s_barrier
    v_lshrrev_b32 v34, 2, v2
    v_bfe_u32 v35, v2, 1, 1
    v_lshl_or_b32 v36, v3, 2, v34
    v_xor_b32 v36, v36, v35
    s_lshl_b32 s85, s48, 1
    v_xor_b32 v36, s85, v36
    v_lshlrev_b32 v36, 4, v36
    v_lshlrev_b32 v201, 4, v34
    v_lshl_add_u32 v201, v3, 1, v201
    v_lshl_add_u32 v201, v201, 8, v36
    v_and_b32 v36, 1, v2
    v_lshl_add_u32 v201, v36, 3, v201
    ds_read_b64_tr_b16 v[144:145], v201 offset:12288
    ds_read_b64_tr_b16 v[146:147], v201 offset:12544
    ds_read_b64_tr_b16 v[148:149], v201 offset:14336
    ds_read_b64_tr_b16 v[150:151], v201 offset:14592
    ds_read_b64_tr_b16 v[152:153], v201 offset:28672
    ds_read_b64_tr_b16 v[154:155], v201 offset:28928
    ds_read_b64_tr_b16 v[156:157], v201 offset:30720
    ds_read_b64_tr_b16 v[158:159], v201 offset:30976
    v_lshl_add_u32 v200, v3, 3, v34
    v_lshlrev_b32 v200, 7, v200
    v_lshl_add_u32 v200, v36, 3, v200
    s_lshl_b32 s85, s48, 12
    s_add_u32 s85, s85, 45056
    v_add_u32 v200, s85, v200
    v_lshrrev_b32 v34, 1, v34
    v_lshl_or_b32 v34, v3, 1, v34
    v_xor_b32 v34, v34, v35
    s_waitcnt lgkmcnt(0)
    v_xor_b32 v36, 0, v34
    v_lshl_add_u32 v36, v36, 4, v200
    ds_read_b64_tr_b16 v[160:161], v36 offset:0
    ds_read_b64_tr_b16 v[162:163], v36 offset:512
    ds_read_b64_tr_b16 v[176:177], v36 offset:32768
    ds_read_b64_tr_b16 v[178:179], v36 offset:33280
    v_xor_b32 v36, 2, v34
    v_lshl_add_u32 v36, v36, 4, v200
    ds_read_b64_tr_b16 v[164:165], v36 offset:0
    ds_read_b64_tr_b16 v[166:167], v36 offset:512
    ds_read_b64_tr_b16 v[180:181], v36 offset:32768
    ds_read_b64_tr_b16 v[182:183], v36 offset:33280
    s_waitcnt lgkmcnt(0)
    v_xor_b32 v36, 4, v34
    v_lshl_add_u32 v36, v36, 4, v200
    ds_read_b64_tr_b16 v[168:169], v36 offset:0
    ds_read_b64_tr_b16 v[170:171], v36 offset:512
    ds_read_b64_tr_b16 v[184:185], v36 offset:32768
    ds_read_b64_tr_b16 v[186:187], v36 offset:33280
    v_xor_b32 v36, 6, v34
    v_lshl_add_u32 v36, v36, 4, v200
    ds_read_b64_tr_b16 v[172:173], v36 offset:0
    ds_read_b64_tr_b16 v[174:175], v36 offset:512
    ds_read_b64_tr_b16 v[188:189], v36 offset:32768
    ds_read_b64_tr_b16 v[190:191], v36 offset:33280
    s_waitcnt lgkmcnt(0)
    s_and_b32 s82, s58, 15
    v_mul_u32_u24 v7, 4, v1
    v_add_u32 v7, s82, v7
    v_subrev_u32 v38, 16, v7
    v_min_u32 v7, v7, v38
    v_lshlrev_b32 v7, 6, v7
    v_lshlrev_b32 v7, 1, v7
    s_lshl_b32 s83, s48, 11
    s_lshr_b32 s82, s56, 4
    s_lshl_b32 s82, s82, 6
    s_add_u32 s83, s83, s82
    s_add_u32 s83, s83, 614432
    s_mov_b64 s[60:61], 0xffff
    s_mov_b64 s[62:63], 0xf
    s_mov_b32 s51, 0
L_poll_14:
    s_mov_b64 exec, s[60:61]
    buffer_load_dword v96, v5, s[44:47], s53 offen offset:4 sc1
    s_mov_b64 exec, s[62:63]
    buffer_load_dword v97, v7, s[44:47], s83 offen sc1
    s_mov_b64 exec, -1
    s_waitcnt vmcnt(0)
    v_cmp_eq_u32 s[76:77], -1, v96
    s_and_b64 s[60:61], s[60:61], s[76:77]
    v_cmp_eq_u32 s[76:77], -1, v97
    s_and_b64 s[62:63], s[62:63], s[76:77]
    s_or_b64 s[78:79], s[60:61], s[62:63]
    s_cbranch_scc0 L_polld_15
    s_add_u32 s51, s51, 1
    s_cmp_gt_u32 s51, 200000
    s_cbranch_scc1 L_polld_15
    s_sleep 3
    s_branch L_poll_14
L_polld_15:
    s_mov_b64 s[60:61], -1
    s_mov_b64 s[62:63], -1
    s_mov_b64 s[64:65], -1
    s_mov_b64 s[66:67], -1
    s_mov_b64 s[68:69], -1
    s_mov_b32 s51, 0
L_poll_16:
    s_mov_b64 exec, s[60:61]
    buffer_load_dwordx4 v[108:111], v6, s[44:47], s54 offen sc1
    s_mov_b64 exec, s[62:63]
    buffer_load_dwordx4 v[112:115], v6, s[44:47], s55 offen sc1
    s_mov_b64 exec, s[64:65]
    buffer_load_dwordx4 v[116:119], v6, s[44:47], s95 offen sc1
    s_mov_b64 exec, s[66:67]
    buffer_load_dwordx4 v[120:123], v6, s[44:47], s80 offen sc1
    s_mov_b64 exec, s[68:69]
    buffer_load_dwordx2 v[104:105], v5, s[44:47], s52 offen sc1
    s_mov_b64 exec, -1
    s_waitcnt vmcnt(0)
    v_max_u32 v39, v108, v109
    v_max3_u32 v39, v39, v110, v111
    v_cmp_eq_u32 s[76:77], -1, v39
    s_and_b64 s[60:61], s[60:61], s[76:77]
    v_max_u32 v39, v112, v113
    v_max3_u32 v39, v39, v114, v115
    v_cmp_eq_u32 s[76:77], -1, v39
    s_and_b64 s[62:63], s[62:63], s[76:77]
    s_or_b64 s[78:79], s[60:61], s[62:63]
    v_max_u32 v39, v116, v117
    v_max3_u32 v39, v39, v118, v119
    v_cmp_eq_u32 s[76:77], -1, v39
    s_and_b64 s[64:65], s[64:65], s[76:77]
    s_or_b64 s[78:79], s[78:79], s[64:65]
    v_max_u32 v39, v120, v121
    v_max3_u32 v39, v39, v122, v123
    v_cmp_eq_u32 s[76:77], -1, v39
    s_and_b64 s[66:67], s[66:67], s[76:77]
    s_or_b64 s[78:79], s[78:79], s[66:67]
    v_cmp_gt_i32 s[76:77], 0, v105
    s_and_b64 s[68:69], s[68:69], s[76:77]
    s_or_b64 s[78:79], s[78:79], s[68:69]
    s_cbranch_scc0 L_polld_17
    s_add_u32 s51, s51, 1
    s_cmp_gt_u32 s51, 200000
    s_cbranch_scc1 L_polld_17
    s_sleep 1
    s_branch L_poll_16
L_polld_17:
    v_mov_b32 v16, v104
    s_nop 1
    v_max_f32_dpp v16, v16, v16 row_shr:1 row_mask:0xf bank_mask:0xf
    s_nop 1
    v_max_f32_dpp v16, v16, v16 row_shr:2 row_mask:0xf bank_mask:0xf
    s_nop 1
    v_max_f32_dpp v16, v16, v16 row_shr:4 row_mask:0xf bank_mask:0xf
    s_nop 1
    v_max_f32_dpp v16, v16, v16 row_shr:8 row_mask:0xf bank_mask:0xf
    s_nop 1
    v_max_f32_dpp v16, v16, v16 row_bcast:15 row_mask:0xa bank_mask:0xf
    s_nop 1
    v_max_f32_dpp v16, v16, v16 row_bcast:31 row_mask:0xc bank_mask:0xf
    s_nop 0
    v_readlane_b32 s52, v16, 63
    s_nop 1
    v_mov_b32 v17, s52
    v_mul_f32 v17, s94, v17
    v_fma_f32 v20, v104, s94, -v17
    v_exp_f32 v20, v20
    s_nop 0
    v_cvt_pk_bf16_f32 v20, v20, v20
    v_lshlrev_b32 v20, 16, v20
    ds_bpermute_b32 v97, v4, v20 offset:0
    ds_bpermute_b32 v99, v4, v20 offset:16
    ds_bpermute_b32 v101, v4, v20 offset:32
    ds_bpermute_b32 v103, v4, v20 offset:48
    v_mul_f32 v21, v20, v105
    v_mov_b32 v8, 0
    v_mov_b32 v9, 0
    v_mov_b32 v10, 0
    v_mov_b32 v11, 0
    v_mov_b32 v12, 0
    v_mov_b32 v13, 0
    v_mov_b32 v14, 0
    v_mov_b32 v15, 0
    v_add_f32_dpp v21, v21, v21 row_shr:1 row_mask:0xf bank_mask:0xf bound_ctrl:0
    s_nop 1
    v_add_f32_dpp v21, v21, v21 row_shr:2 row_mask:0xf bank_mask:0xf bound_ctrl:0
    s_nop 1
    v_add_f32_dpp v21, v21, v21 row_shr:4 row_mask:0xf bank_mask:0xf bound_ctrl:0
    s_nop 1
    v_add_f32_dpp v21, v21, v21 row_shr:8 row_mask:0xf bank_mask:0xf bound_ctrl:0
    s_nop 1
    v_add_f32_dpp v21, v21, v21 row_bcast:15 row_mask:0xa bank_mask:0xf
    s_nop 1
    v_add_f32_dpp v21, v21, v21 row_bcast:31 row_mask:0xc bank_mask:0xf
    s_nop 0
    v_readlane_b32 s52, v21, 63
    s_waitcnt lgkmcnt(3)
    v_lshrrev_b32 v96, 16, v97
    v_dot2c_f32_bf16 v9, v108, v97
    v_dot2c_f32_bf16 v11, v109, v97
    v_dot2c_f32_bf16 v13, v110, v97
    v_dot2c_f32_bf16 v15, v111, v97
    v_dot2c_f32_bf16 v8, v108, v96
    v_dot2c_f32_bf16 v10, v109, v96
    v_dot2c_f32_bf16 v12, v110, v96
    v_dot2c_f32_bf16 v14, v111, v96
    s_waitcnt lgkmcnt(2)
    v_lshrrev_b32 v98, 16, v99
    v_dot2c_f32_bf16 v9, v112, v99
    v_dot2c_f32_bf16 v11, v113, v99
    v_dot2c_f32_bf16 v13, v114, v99
    v_dot2c_f32_bf16 v15, v115, v99
    v_dot2c_f32_bf16 v8, v112, v98
    v_dot2c_f32_bf16 v10, v113, v98
    v_dot2c_f32_bf16 v12, v114, v98
    v_dot2c_f32_bf16 v14, v115, v98
    s_waitcnt lgkmcnt(1)
    v_lshrrev_b32 v100, 16, v101
    v_dot2c_f32_bf16 v9, v116, v101
    v_dot2c_f32_bf16 v11, v117, v101
    v_dot2c_f32_bf16 v13, v118, v101
    v_dot2c_f32_bf16 v15, v119, v101
    v_dot2c_f32_bf16 v8, v116, v100
    v_dot2c_f32_bf16 v10, v117, v100
    v_dot2c_f32_bf16 v12, v118, v100
    v_dot2c_f32_bf16 v14, v119, v100
    s_waitcnt lgkmcnt(0)
    v_lshrrev_b32 v102, 16, v103
    v_dot2c_f32_bf16 v9, v120, v103
    v_dot2c_f32_bf16 v11, v121, v103
    v_dot2c_f32_bf16 v13, v122, v103
    v_dot2c_f32_bf16 v15, v123, v103
    v_dot2c_f32_bf16 v8, v120, v102
    v_dot2c_f32_bf16 v10, v121, v102
    v_dot2c_f32_bf16 v12, v122, v102
    v_dot2c_f32_bf16 v14, v123, v102
    v_rcp_f32 v16, s52
    s_nop 0
    v_permlane32_swap_b32 v8, v12
    v_permlane32_swap_b32 v9, v13
    v_permlane32_swap_b32 v10, v14
    v_permlane32_swap_b32 v11, v15
    v_add_f32 v8, v8, v12
    v_add_f32 v9, v9, v13
    v_add_f32 v10, v10, v14
    v_add_f32 v11, v11, v15
    s_nop 0
    v_permlane16_swap_b32 v8, v10
    v_permlane16_swap_b32 v9, v11
    v_add_f32 v8, v8, v10
    v_add_f32 v9, v9, v11
    v_mul_f32 v8, v8, v16
    v_mul_f32 v9, v9, v16
    v_cvt_pk_bf16_f32 v10, v8, v9
    v_lshlrev_b32 v11, 16, v10
    v_and_b32 v12, 0xffff0000, v10
    v_sub_f32 v8, v8, v11
    v_sub_f32 v9, v9, v12
    v_cvt_pk_bf16_f32 v11, v8, v9
    ds_write2_b32 v192, v10, v11 offset0:0 offset1:68
    s_branch L_c1_1
L_S_2:
    s_sub_u32 s55, s48, 4
    s_cmp_lg_u32 s48, 4
    s_cbranch_scc1 L_c_18
    s_lshl_b32 s52, s2, 7
    s_add_u32 s52, s52, 589824
    s_mov_b32 exec_lo, 0xff
    s_mov_b32 exec_hi, 0x0
    buffer_store_dwordx4 v[44:47], v41, s[44:47], s52 offen sc1
    s_lshl_b32 s52, s2, 6
    s_add_u32 s52, s52, 647168
    s_mov_b32 exec_lo, 0xf
    s_mov_b32 exec_hi, 0x0
    buffer_store_dwordx4 v[44:47], v41, s[44:47], s52 offen sc1
    s_lshr_b32 s52, s56, 4
    s_lshl_b32 s52, s52, 7
    s_and_b32 s53, s56, 15
    s_lshl_b32 s53, s53, 3
    s_add_u32 s52, s52, s53
    s_lshl_b32 s53, s57, 12
    s_add_u32 s52, s52, s53
    s_add_u32 s52, s52, 147456
    s_mov_b32 exec_lo, 0xffff
    s_mov_b32 exec_hi, 0x0
    v_lshlrev_b32 v4, 8, v1
    buffer_store_dwordx2 v[44:45], v4, s[44:47], s52 offen sc1
    s_mov_b64 exec, -1
L_c_18:
    s_lshl_b32 s80, s57, 7
    s_lshl_b32 s53, s55, 5
    s_add_u32 s80, s80, s53
    s_lshl_b32 s80, s80, 13
    s_lshl_b32 s53, s56, 8
    s_add_u32 s80, s80, s53
    v_xor_b32 v6, v2, v3
    v_xor_b32 v8, 0, v6
    v_lshlrev_b32 v8, 4, v8
    v_lshl_add_u32 v8, v3, 13, v8
    v_xor_b32 v9, 4, v6
    v_lshlrev_b32 v9, 4, v9
    v_lshl_add_u32 v9, v3, 13, v9
    v_xor_b32 v10, 8, v6
    v_lshlrev_b32 v10, 4, v10
    v_lshl_add_u32 v10, v3, 13, v10
    v_xor_b32 v11, 12, v6
    v_lshlrev_b32 v11, 4, v11
    v_lshl_add_u32 v11, v3, 13, v11
    s_mov_b32 s52, s80
    s_lshl_b32 s54, s55, 13
    s_add_u32 s54, s54, 90112
    s_barrier
    s_barrier
    s_mov_b32 m0, s54
    s_nop 0
    buffer_load_dwordx4 v8, s[16:19], s52 offen nt lds
    s_add_u32 s52, s52, 32768
    s_add_u32 s54, s54, 1024
    s_mov_b32 m0, s54
    s_nop 0
    buffer_load_dwordx4 v9, s[16:19], s52 offen nt lds
    s_add_u32 s52, s52, 32768
    s_add_u32 s54, s54, 1024
    s_mov_b32 m0, s54
    s_nop 0
    buffer_load_dwordx4 v10, s[16:19], s52 offen nt lds
    s_add_u32 s52, s52, 32768
    s_add_u32 s54, s54, 1024
    s_mov_b32 m0, s54
    s_nop 0
    buffer_load_dwordx4 v11, s[16:19], s52 offen nt lds
    s_add_u32 s52, s52, 32768
    s_add_u32 s54, s54, 1024
    s_mov_b32 m0, s54
    s_nop 0
    buffer_load_dwordx4 v8, s[16:19], s52 offen nt lds
    s_add_u32 s52, s52, 32768
    s_add_u32 s54, s54, 1024
    s_mov_b32 m0, s54
    s_nop 0
    buffer_load_dwordx4 v9, s[16:19], s52 offen nt lds
    s_add_u32 s52, s52, 32768
    s_add_u32 s54, s54, 1024
    s_mov_b32 m0, s54
    s_nop 0
    buffer_load_dwordx4 v10, s[16:19], s52 offen nt lds
    s_add_u32 s52, s52, 32768
    s_add_u32 s54, s54, 1024
    s_mov_b32 m0, s54
    s_nop 0
    buffer_load_dwordx4 v11, s[16:19], s52 offen nt lds
    s_waitcnt vmcnt(8)
    s_barrier
    s_waitcnt vmcnt(0)
    s_barrier
    s_barrier
    v_lshrrev_b32 v6, 1, v3
    v_lshlrev_b32 v6, 2, v6
    v_xor_b32 v6, v6, v2
    s_and_b32 s52, s55, 1
    s_lshl_b32 s52, s52, 1
    v_xor_b32 v6, s52, v6
    v_xor_b32 v8, 0, v6
    v_lshlrev_b32 v8, 4, v8
    v_lshl_add_u32 v8, v3, 13, v8
    v_xor_b32 v9, 8, v6
    v_lshlrev_b32 v9, 4, v9
    v_lshl_add_u32 v9, v3, 13, v9
    v_xor_b32 v10, 1, v6
    v_lshlrev_b32 v10, 4, v10
    v_lshl_add_u32 v10, v3, 13, v10
    v_xor_b32 v11, 9, v6
    v_lshlrev_b32 v11, 4, v11
    v_lshl_add_u32 v11, v3, 13, v11
    s_mov_b32 s52, s80
    s_lshl_b32 s54, s55, 13
    s_add_u32 s54, s54, 12288
    s_mov_b32 m0, s54
    s_nop 0
    buffer_load_dwordx4 v8, s[20:23], s52 offen nt lds
    s_add_u32 s52, s52, 32768
    s_add_u32 s54, s54, 1024
    s_mov_b32 m0, s54
    s_nop 0
    buffer_load_dwordx4 v9, s[20:23], s52 offen nt lds
    s_add_u32 s52, s52, 32768
    s_add_u32 s54, s54, 1024
    s_mov_b32 m0, s54
    s_nop 0
    buffer_load_dwordx4 v8, s[20:23], s52 offen nt lds
    s_add_u32 s52, s52, 32768
    s_add_u32 s54, s54, 1024
    s_mov_b32 m0, s54
    s_nop 0
    buffer_load_dwordx4 v9, s[20:23], s52 offen nt lds
    s_add_u32 s52, s52, 32768
    s_add_u32 s54, s54, 1024
    s_mov_b32 m0, s54
    s_nop 0
    buffer_load_dwordx4 v10, s[20:23], s52 offen nt lds
    s_add_u32 s52, s52, 32768
    s_add_u32 s54, s54, 1024
    s_mov_b32 m0, s54
    s_nop 0
    buffer_load_dwordx4 v11, s[20:23], s52 offen nt lds
    s_add_u32 s52, s52, 32768
    s_add_u32 s54, s54, 1024
    s_mov_b32 m0, s54
    s_nop 0
    buffer_load_dwordx4 v10, s[20:23], s52 offen nt lds
    s_add_u32 s52, s52, 32768
    s_add_u32 s54, s54, 1024
    s_mov_b32 m0, s54
    s_nop 0
    buffer_load_dwordx4 v11, s[20:23], s52 offen nt lds
    s_cmp_ge_u32 s2, 120
    s_cbranch_scc1 L_no_19
    v_lshrrev_b32 v4, 3, v1
    v_mul_u32_u24 v4, 1280, v4
    v_and_b32 v5, 7, v1
    v_and_b32 v6, 1, v3
    v_xor_b32 v5, v5, v6
    s_lshl_b32 s52, s55, 1
    v_xor_b32 v5, s52, v5
    v_lshl_add_u32 v4, v5, 4, v4
    s_lshl_b32 s52, s100, 2
    s_add_u32 s52, s52, s55
    s_mul_i32 s52, s52, 10240
    s_lshl_b32 s53, s98, 7
    s_add_u32 s52, s52, s53
    s_lshl_b32 s54, s55, 10
    s_add_u32 s54, s54, 45056
    s_mov_b32 m0, s54
    s_nop 0
    buffer_load_dwordx4 v4, s[24:27], s52 offen nt lds
    s_add_u32 s52, s52, 40960
    s_add_u32 s54, s54, 4096
    s_mov_b32 m0, s54
    s_nop 0
    buffer_load_dwordx4 v4, s[24:27], s52 offen nt lds
    s_add_u32 s52, s52, 40960
    s_add_u32 s54, s54, 4096
    s_mov_b32 m0, s54
    s_nop 0
    buffer_load_dwordx4 v4, s[24:27], s52 offen nt lds
    s_add_u32 s52, s52, 40960
    s_add_u32 s54, s54, 4096
    s_mov_b32 m0, s54
    s_nop 0
    buffer_load_dwordx4 v4, s[24:27], s52 offen nt lds
    s_add_u32 s52, s52, 40960
    s_add_u32 s54, s54, 4096
    s_mov_b32 m0, s54
    s_nop 0
    buffer_load_dwordx4 v4, s[24:27], s52 offen nt lds
    s_add_u32 s52, s52, 40960
    s_add_u32 s54, s54, 4096
    s_mov_b32 m0, s54
    s_nop 0
    buffer_load_dwordx4 v4, s[24:27], s52 offen nt lds
    s_add_u32 s52, s52, 40960
    s_add_u32 s54, s54, 4096
    s_mov_b32 m0, s54
    s_nop 0
    buffer_load_dwordx4 v4, s[24:27], s52 offen nt lds
    s_add_u32 s52, s52, 40960
    s_add_u32 s54, s54, 4096
    s_mov_b32 m0, s54
    s_nop 0
    buffer_load_dwordx4 v4, s[24:27], s52 offen nt lds
    s_add_u32 s52, s52, 40960
    s_add_u32 s54, s54, 4096
    s_mov_b32 m0, s54
    s_nop 0
    buffer_load_dwordx4 v4, s[24:27], s52 offen nt lds
    s_add_u32 s52, s52, 40960
    s_add_u32 s54, s54, 4096
    s_mov_b32 m0, s54
    s_nop 0
    buffer_load_dwordx4 v4, s[24:27], s52 offen nt lds
    s_add_u32 s52, s52, 40960
    s_add_u32 s54, s54, 4096
    s_cmp_lt_u32 s101, 11
    s_cbranch_scc1 L_no_19
    s_mov_b32 m0, s54
    s_nop 0
    buffer_load_dwordx4 v4, s[24:27], s52 offen nt lds
L_no_19:
    s_waitcnt vmcnt(0)
    s_barrier
    v_lshrrev_b32 v34, 2, v2
    v_bfe_u32 v35, v2, 1, 1
    v_lshl_or_b32 v36, v3, 2, v34
    v_xor_b32 v36, v36, v35
    s_lshl_b32 s85, s48, 1
    v_xor_b32 v36, s85, v36
    v_lshlrev_b32 v36, 4, v36
    v_lshlrev_b32 v201, 4, v34
    v_lshl_add_u32 v201, v3, 1, v201
    v_lshl_add_u32 v201, v201, 8, v36
    v_and_b32 v36, 1, v2
    v_lshl_add_u32 v201, v36, 3, v201
    ds_read_b64_tr_b16 v[144:145], v201 offset:12288
    ds_read_b64_tr_b16 v[146:147], v201 offset:12544
    ds_read_b64_tr_b16 v[148:149], v201 offset:14336
    ds_read_b64_tr_b16 v[150:151], v201 offset:14592
    ds_read_b64_tr_b16 v[152:153], v201 offset:28672
    ds_read_b64_tr_b16 v[154:155], v201 offset:28928
    ds_read_b64_tr_b16 v[156:157], v201 offset:30720
    ds_read_b64_tr_b16 v[158:159], v201 offset:30976
    v_lshl_add_u32 v200, v3, 3, v34
    v_lshlrev_b32 v200, 7, v200
    v_lshl_add_u32 v200, v36, 3, v200
    s_lshl_b32 s85, s48, 12
    s_add_u32 s85, s85, 45056
    v_add_u32 v200, s85, v200
    v_lshrrev_b32 v34, 1, v34
    v_lshl_or_b32 v34, v3, 1, v34
    v_xor_b32 v34, v34, v35
    s_waitcnt lgkmcnt(0)
    v_xor_b32 v36, 0, v34
    v_lshl_add_u32 v36, v36, 4, v200
    ds_read_b64_tr_b16 v[160:161], v36 offset:0
    ds_read_b64_tr_b16 v[162:163], v36 offset:512
    ds_read_b64_tr_b16 v[176:177], v36 offset:32768
    ds_read_b64_tr_b16 v[178:179], v36 offset:33280
    v_xor_b32 v36, 2, v34
    v_lshl_add_u32 v36, v36, 4, v200
    ds_read_b64_tr_b16 v[164:165], v36 offset:0
    ds_read_b64_tr_b16 v[166:167], v36 offset:512
    ds_read_b64_tr_b16 v[180:181], v36 offset:32768
    ds_read_b64_tr_b16 v[182:183], v36 offset:33280
    s_waitcnt lgkmcnt(0)
    v_xor_b32 v36, 4, v34
    v_lshl_add_u32 v36, v36, 4, v200
    ds_read_b64_tr_b16 v[168:169], v36 offset:0
    ds_read_b64_tr_b16 v[170:171], v36 offset:512
    ds_read_b64_tr_b16 v[184:185], v36 offset:32768
    ds_read_b64_tr_b16 v[186:187], v36 offset:33280
    v_xor_b32 v36, 6, v34
    v_lshl_add_u32 v36, v36, 4, v200
    ds_read_b64_tr_b16 v[172:173], v36 offset:0
    ds_read_b64_tr_b16 v[174:175], v36 offset:512
    ds_read_b64_tr_b16 v[188:189], v36 offset:32768
    ds_read_b64_tr_b16 v[190:191], v36 offset:33280
    s_waitcnt lgkmcnt(0)
L_c1_1:
    s_lshl_b32 s53, s48, 5
    s_lshl_b32 s52, s58, 8
    s_add_u32 s52, s52, s53
    s_add_u32 s52, s52, 32768
    s_waitcnt lgkmcnt(0)
    s_barrier
    s_mov_b32 exec_lo, 0xff00ff
    s_mov_b32 exec_hi, 0xff00ff
    ds_read_b128 v[128:131], v193 offset:0
    ds_read_b128 v[132:135], v193 offset:64
    ds_read_b128 v[136:139], v193 offset:128
    ds_read_b128 v[140:143], v193 offset:192
    s_mov_b64 exec, -1
    s_waitcnt lgkmcnt(3)
    v_mfma_f32_16x16x32_bf16 v[8:11], v[128:131], v[144:147], 0
    s_waitcnt lgkmcnt(2)
    v_mfma_f32_16x16x32_bf16 v[8:11], v[132:135], v[148:151], v[8:11]
    s_waitcnt lgkmcnt(1)
    v_mfma_f32_16x16x32_bf16 v[8:11], v[136:139], v[152:155], v[8:11]
    s_waitcnt lgkmcnt(0)
    v_mfma_f32_16x16x32_bf16 v[8:11], v[140:143], v[156:159], v[8:11]
    s_nop 7
    v_add_f32 v8, v8, v9
    v_add_f32 v10, v10, v11
    v_add_f32 v8, v8, v10
    v_mov_b32 v9, v8
    s_nop 1
    v_permlane16_swap_b32 v8, v9
    v_add_f32 v8, v8, v9
    s_nop 1
    v_mov_b32_dpp v9, v8 row_shl:1 row_mask:0xf bank_mask:0xf bound_ctrl:0
    v_cvt_pk_bf16_f32 v8, v8, v9
    v_min_u32 v8, -2, v8
    s_mov_b32 exec_lo, 0x5555
    s_mov_b32 exec_hi, 0x0
    buffer_store_dword v8, v194, s[44:47], s52 offen sc1
    s_mov_b64 exec, -1
    s_cmp_ge_u32 s2, 120
    s_cbranch_scc1 L_fin
    v_lshlrev_b32 v4, 8, v2
    v_lshl_add_u32 v4, v3, 4, v4
    s_add_u32 s53, s100, s48
    s_lshr_b32 s52, s53, 2
    s_lshl_b32 s52, s52, 10
    s_and_b32 s53, s53, 3
    s_lshl_b32 s53, s53, 6
    s_add_u32 s52, s52, s53
    s_add_u32 s52, s52, 32768
    v_mov_b32 v204, 0
    v_mov_b32 v205, 0
    v_mov_b32 v206, 0
    v_mov_b32 v207, 0
    v_mov_b32 v208, 0
    v_mov_b32 v209, 0
    v_mov_b32 v210, 0
    v_mov_b32 v211, 0
    s_mov_b32 s90, 0x000f000f
    s_mov_b32 s91, 0x000f000f
    s_add_u32 s53, s48, 8
    s_cmp_lt_u32 s53, s101
    s_cselect_b64 s[92:93], s[90:91], 0
    s_cselect_b32 s95, 1, 0
    v_lshlrev_b32 v5, 2, v1
    s_lshl_b32 s53, s48, 8
    v_add_u32 v6, s53, v5
    s_lshl_b32 s54, s2, 6
    s_add_u32 s54, s54, 647168
    s_sleep 4
    s_mov_b64 s[60:61], s[90:91]
    s_mov_b64 s[62:63], s[92:93]
    s_mov_b32 s51, 0
L_poll_20:
    s_mov_b64 exec, s[60:61]
    buffer_load_dwordx4 v[204:207], v4, s[44:47], s52 offen offset:0 sc1
    s_mov_b64 exec, s[62:63]
    buffer_load_dwordx4 v[208:211], v4, s[44:47], s52 offen offset:2048 sc1
    s_mov_b64 exec, -1
    s_waitcnt vmcnt(0)
    v_max_u32 v39, v204, v205
    v_max3_u32 v39, v39, v206, v207
    v_cmp_eq_u32 s[76:77], -1, v39
    s_and_b64 s[60:61], s[60:61], s[76:77]
    v_max_u32 v39, v208, v209
    v_max3_u32 v39, v39, v210, v211
    v_cmp_eq_u32 s[76:77], -1, v39
    s_and_b64 s[62:63], s[62:63], s[76:77]
    s_or_b64 s[78:79], s[60:61], s[62:63]
    s_cbranch_scc0 L_polld_21
    s_add_u32 s51, s51, 1
    s_cmp_gt_u32 s51, 200000
    s_cbranch_scc1 L_polld_21
    s_sleep 1
    s_branch L_poll_20
L_polld_21:
    s_cmp_lg_u32 s48, 0
    s_cbranch_scc1 L_ew_22
    v_mov_b32 v7, 1
    v_mov_b32 v38, 0
    s_mov_b32 exec_lo, 0x1
    s_mov_b32 exec_hi, 0x0
    buffer_store_dword v7, v38, s[44:47], s54 offen sc1
    s_mov_b64 exec, -1
L_ew_22:
    s_waitcnt lgkmcnt(0)
    v_mfma_f32_16x16x32_bf16 v[8:11], v[204:207], v[160:163], 0
    v_mfma_f32_16x16x32_bf16 v[12:15], v[204:207], v[164:167], 0
    v_mfma_f32_16x16x32_bf16 v[16:19], v[204:207], v[168:171], 0
    v_mfma_f32_16x16x32_bf16 v[20:23], v[204:207], v[172:175], 0
    s_cmp_eq_u32 s95, 0
    s_cbranch_scc1 L_2u_23
    v_mfma_f32_16x16x32_bf16 v[8:11], v[208:211], v[176:179], v[8:11]
    v_mfma_f32_16x16x32_bf16 v[12:15], v[208:211], v[180:183], v[12:15]
    v_mfma_f32_16x16x32_bf16 v[16:19], v[208:211], v[184:187], v[16:19]
    v_mfma_f32_16x16x32_bf16 v[20:23], v[208:211], v[188:191], v[20:23]
L_2u_23:
    s_lshl_b32 s52, s2, 7
    s_add_u32 s52, s52, 589824
    s_mov_b32 exec_lo, 0xffff
    s_mov_b32 exec_hi, 0x0
    s_nop 4
    v_add_f32 v8, v8, v9
    v_add_f32 v10, v10, v11
    v_add_f32 v8, v8, v10
    ds_write_b32 v6, v8 offset:0
    v_add_f32 v12, v12, v13
    v_add_f32 v14, v14, v15
    v_add_f32 v12, v12, v14
    ds_write_b32 v6, v12 offset:64
    v_add_f32 v16, v16, v17
    v_add_f32 v18, v18, v19
    v_add_f32 v16, v16, v18
    ds_write_b32 v6, v16 offset:128
    v_add_f32 v20, v20, v21
    v_add_f32 v22, v22, v23
    v_add_f32 v20, v20, v22
    ds_write_b32 v6, v20 offset:192
    s_mov_b64 exec, -1
    s_waitcnt lgkmcnt(0)
    s_barrier
    s_cmp_lg_u32 s48, 0
    s_cbranch_scc1 L_fin
    v_lshlrev_b32 v6, 3, v1
    s_mov_b32 exec_lo, 0xffffffff
    s_mov_b32 exec_hi, 0x0
    ds_read_b64 v[212:213], v6 offset:0
    ds_read_b64 v[214:215], v6 offset:256
    ds_read_b64 v[216:217], v6 offset:512
    ds_read_b64 v[218:219], v6 offset:768
    ds_read_b64 v[220:221], v6 offset:1024
    ds_read_b64 v[222:223], v6 offset:1280
    ds_read_b64 v[224:225], v6 offset:1536
    ds_read_b64 v[226:227], v6 offset:1792
    s_waitcnt lgkmcnt(0)
    v_pk_add_f32 v[212:213], v[212:213], v[220:221]
    v_pk_add_f32 v[214:215], v[214:215], v[222:223]
    v_pk_add_f32 v[216:217], v[216:217], v[224:225]
    v_pk_add_f32 v[218:219], v[218:219], v[226:227]
    v_pk_add_f32 v[212:213], v[212:213], v[216:217]
    v_pk_add_f32 v[214:215], v[214:215], v[218:219]
    v_pk_add_f32 v[212:213], v[212:213], v[214:215]
    v_cvt_pk_bf16_f32 v212, v212, v213
    v_min_u32 v212, -2, v212
    buffer_store_dword v212, v5, s[44:47], s52 offen sc1
    s_mov_b64 exec, -1
    s_branch L_fin
L_Y:
    s_lshl_b32 s56, s50, 3
    s_lshr_b32 s52, s49, 1
    s_add_u32 s56, s56, s52
    s_and_b32 s57, s49, 1
    s_lshl_b32 s58, s56, 1
    s_add_u32 s58, s58, s57
    s_lshr_b32 s53, s49, 1
    s_lshl_b32 s53, s53, 3
    s_add_u32 s53, s53, s50
    s_and_b32 s52, s49, 1
    s_lshl_b32 s59, s53, 1
    s_add_u32 s59, s59, s52
    s_cmp_lt_u32 s53, 27
    s_cselect_b32 s88, 1, 0
    s_cmp_lt_u32 s53, 20
    s_cselect_b32 s89, 1, 0
    s_cmp_eq_u32 s52, 0
    s_cselect_b32 s89, s89, 0
    s_waitcnt lgkmcnt(0)
    s_mov_b64 s[44:45], s[86:87]
    s_mov_b64 s[4:5], s[64:65]
    s_mov_b64 s[12:13], s[68:69]
    s_mov_b64 s[8:9], s[66:67]
    s_mov_b64 s[16:17], s[70:71]
    s_mov_b64 s[40:41], s[84:85]
    s_mov_b64 s[20:21], s[72:73]
    s_mov_b64 s[24:25], s[74:75]
    s_mov_b64 s[28:29], s[78:79]
    s_mov_b64 s[32:33], s[80:81]
    s_mov_b64 s[36:37], s[82:83]
    s_cmp_lt_u32 s2, 248
    s_cbranch_scc1 L_c_24
    s_lshl_b32 s54, s50, 13
    s_lshl_b32 s55, s48, 10
    s_add_u32 s54, s54, s55
    s_add_u32 s54, s54, 73728
    buffer_store_dwordx4 v[44:47], v41, s[44:47], s54 offen sc1
    s_lshl_b32 s54, s50, 12
    s_and_b32 s55, s48, 3
    s_lshl_b32 s55, s55, 10
    s_add_u32 s54, s54, s55
    s_lshr_b32 s55, s48, 2
    s_lshl_b32 s55, s55, 15
    s_add_u32 s54, s54, s55
    buffer_store_dwordx4 v[44:47], v41, s[44:47], s54 offen sc1
    s_cmp_lt_u32 s48, 6
    s_cbranch_scc1 L_c_25
    s_lshl_b32 s54, s50, 10
    s_mov_b32 s55, 65536
    s_cmp_eq_u32 s48, 6
    s_cselect_b32 s55, 614400, s55
    s_add_u32 s54, s54, s55
    buffer_store_dwordx4 v[44:47], v41, s[44:47], s54 offen sc1
L_c_25:
    s_waitcnt vmcnt(0)
    s_barrier
    s_cmp_lg_u32 s48, 0
    s_cbranch_scc1 L_c_26
    s_lshl_b32 s54, s50, 5
    v_mov_b32 v7, 1
    s_mov_b32 exec_lo, 0x1
    s_mov_b32 exec_hi, 0x0
    buffer_store_dword v7, v41, s[40:43], s54 offen sc1
    s_mov_b64 exec, -1
L_c_26:
    s_barrier
L_c_24:
    s_lshl_b32 s52, s56, 7
    s_lshl_b32 s54, s48, 4
    s_add_u32 s52, s52, s54
    s_lshl_b32 s52, s52, 10
    s_mul_i32 s54, s54, 1040
    s_add_u32 s54, s54, 28928
    s_xor_b32 s55, s57, 0
    s_lshl_b32 s53, s55, 13
    s_add_u32 s53, s53, s52
    s_mul_i32 s55, s55, 8320
    s_add_u32 s55, s55, s54
    s_mov_b32 m0, s55
    s_nop 0
    buffer_load_dwordx4 v41, s[8:11], s53 offen nt lds
    s_add_u32 s53, s53, 1024
    s_add_u32 s55, s55, 1040
    s_mov_b32 m0, s55
    s_nop 0
    buffer_load_dwordx4 v41, s[8:11], s53 offen nt lds
    s_add_u32 s53, s53, 1024
    s_add_u32 s55, s55, 1040
    s_mov_b32 m0, s55
    s_nop 0
    buffer_load_dwordx4 v41, s[8:11], s53 offen nt lds
    s_add_u32 s53, s53, 1024
    s_add_u32 s55, s55, 1040
    s_mov_b32 m0, s55
    s_nop 0
    buffer_load_dwordx4 v41, s[8:11], s53 offen nt lds
    s_add_u32 s53, s53, 1024
    s_add_u32 s55, s55, 1040
    s_mov_b32 m0, s55
    s_nop 0
    buffer_load_dwordx4 v41, s[8:11], s53 offen nt lds
    s_add_u32 s53, s53, 1024
    s_add_u32 s55, s55, 1040
    s_mov_b32 m0, s55
    s_nop 0
    buffer_load_dwordx4 v41, s[8:11], s53 offen nt lds
    s_add_u32 s53, s53, 1024
    s_add_u32 s55, s55, 1040
    s_mov_b32 m0, s55
    s_nop 0
    buffer_load_dwordx4 v41, s[8:11], s53 offen nt lds
    s_add_u32 s53, s53, 1024
    s_add_u32 s55, s55, 1040
    s_mov_b32 m0, s55
    s_nop 0
    buffer_load_dwordx4 v41, s[8:11], s53 offen nt lds
    s_xor_b32 s55, s57, 1
    s_lshl_b32 s53, s55, 13
    s_add_u32 s53, s53, s52
    s_mul_i32 s55, s55, 8320
    s_add_u32 s55, s55, s54
    s_mov_b32 m0, s55
    s_nop 0
    buffer_load_dwordx4 v41, s[8:11], s53 offen nt lds
    s_add_u32 s53, s53, 1024
    s_add_u32 s55, s55, 1040
    s_mov_b32 m0, s55
    s_nop 0
    buffer_load_dwordx4 v41, s[8:11], s53 offen nt lds
    s_add_u32 s53, s53, 1024
    s_add_u32 s55, s55, 1040
    s_mov_b32 m0, s55
    s_nop 0
    buffer_load_dwordx4 v41, s[8:11], s53 offen nt lds
    s_add_u32 s53, s53, 1024
    s_add_u32 s55, s55, 1040
    s_mov_b32 m0, s55
    s_nop 0
    buffer_load_dwordx4 v41, s[8:11], s53 offen nt lds
    s_add_u32 s53, s53, 1024
    s_add_u32 s55, s55, 1040
    s_mov_b32 m0, s55
    s_nop 0
    buffer_load_dwordx4 v41, s[8:11], s53 offen nt lds
    s_add_u32 s53, s53, 1024
    s_add_u32 s55, s55, 1040
    s_mov_b32 m0, s55
    s_nop 0
    buffer_load_dwordx4 v41, s[8:11], s53 offen nt lds
    s_add_u32 s53, s53, 1024
    s_add_u32 s55, s55, 1040
    s_mov_b32 m0, s55
    s_nop 0
    buffer_load_dwordx4 v41, s[8:11], s53 offen nt lds
    s_add_u32 s53, s53, 1024
    s_add_u32 s55, s55, 1040
    s_mov_b32 m0, s55
    s_nop 0
    buffer_load_dwordx4 v41, s[8:11], s53 offen nt lds
    s_cmp_eq_u32 s88, 0
    s_cbranch_scc1 L_c_27
    s_cmp_gt_u32 s48, 2
    s_cbranch_scc1 L_c_27
    s_mul_i32 s52, s59, 2560
    s_add_u32 s52, s52, 196608
    v_lshlrev_b32 v7, 4, v0
    v_cmp_gt_u32 vcc, 160, v0
    s_mov_b64 exec, vcc
    buffer_store_dwordx4 v[44:47], v7, s[44:47], s52 offen sc1
    s_mov_b64 exec, -1
L_c_27:
    v_mul_u32_u24 v43, 1040, v2
    v_lshl_add_u32 v43, v3, 4, v43
    s_mul_i32 s52, s48, 16640
    s_add_u32 s52, s52, 28928
    v_add_u32 v5, s52, v43
    s_cmp_lg_u32 s48, 0
    s_cbranch_scc1 L_r_28
    s_mov_b32 s51, 0
L_fl_29:
    s_mov_b32 exec_lo, 0xff
    s_mov_b32 exec_hi, 0x0
    v_lshlrev_b32 v7, 5, v1
    buffer_load_dword v42, v7, s[40:43], 0 offen sc1
    s_mov_b64 exec, -1
L_fl1_31:
    s_waitcnt vmcnt(0)
    s_mov_b32 exec_lo, 0xff
    s_mov_b32 exec_hi, 0x0
    v_cmp_eq_u32 vcc, 0, v42
    s_mov_b64 exec, -1
    s_cbranch_vccz L_fld_30
    s_add_u32 s51, s51, 1
    s_cmp_gt_u32 s51, 200000
    s_cbranch_scc1 L_fld_30
    s_sleep 8
    s_branch L_fl_29
L_fld_30:
L_r_28:
    s_waitcnt vmcnt(0)
    s_lshl_b32 s52, s58, 14
    s_lshl_b32 s53, s48, 11
    s_add_u32 s52, s52, s53
    s_add_u32 s52, s52, 1048576
    buffer_store_dwordx4 v[44:47], v41, s[44:47], s52 offen offset:0 sc1
    buffer_store_dwordx4 v[44:47], v41, s[44:47], s52 offen offset:1024 sc1
    ds_read_b128 v[48:51], v5 offset:0
    ds_read_b128 v[52:55], v5 offset:64
    ds_read_b128 v[56:59], v5 offset:128
    ds_read_b128 v[60:63], v5 offset:192
    ds_read_b128 v[64:67], v5 offset:256
    ds_read_b128 v[68:71], v5 offset:320
    ds_read_b128 v[72:75], v5 offset:384
    ds_read_b128 v[76:79], v5 offset:448
    s_waitcnt lgkmcnt(0)
    ds_read_b128 v[80:83], v5 offset:512
    ds_read_b128 v[84:87], v5 offset:576
    ds_read_b128 v[88:91], v5 offset:640
    ds_read_b128 v[92:95], v5 offset:704
    ds_read_b128 v[96:99], v5 offset:768
    ds_read_b128 v[100:103], v5 offset:832
    ds_read_b128 v[104:107], v5 offset:896
    ds_read_b128 v[108:111], v5 offset:960
    s_barrier
    s_lshl_b32 s52, s57, 4
    s_lshl_b32 s53, s48, 1
    s_add_u32 s52, s52, s53
    s_lshl_b32 s54, s52, 10
    buffer_load_dwordx4 v[240:243], v41, s[44:47], s54 offen offset:0 sc1
    buffer_load_dwordx4 v[244:247], v41, s[44:47], s54 offen offset:1024 sc1
    v_lshrrev_b32 v5, 2, v2
    v_lshl_add_u32 v5, v3, 3, v5
    v_mul_u32_u24 v5, 1040, v5
    v_and_b32 v7, 3, v2
    v_lshl_add_u32 v5, v7, 3, v5
    s_lshl_b32 s52, s48, 7
    s_add_u32 s52, s52, 28928
    v_add_u32 v5, s52, v5
    v_add_u32 v6, 66560, v5
    s_waitcnt lgkmcnt(0)
    ds_read_b64_tr_b16 v[112:113], v5 offset:0
    ds_read_b64_tr_b16 v[114:115], v5 offset:4160
    ds_read_b64_tr_b16 v[116:117], v5 offset:33280
    ds_read_b64_tr_b16 v[118:119], v5 offset:37440
    ds_read_b64_tr_b16 v[120:121], v6 offset:0
    ds_read_b64_tr_b16 v[122:123], v6 offset:4160
    ds_read_b64_tr_b16 v[124:125], v6 offset:33280
    ds_read_b64_tr_b16 v[126:127], v6 offset:37440
    s_waitcnt lgkmcnt(0)
    ds_read_b64_tr_b16 v[128:129], v5 offset:32
    ds_read_b64_tr_b16 v[130:131], v5 offset:4192
    ds_read_b64_tr_b16 v[132:133], v5 offset:33312
    ds_read_b64_tr_b16 v[134:135], v5 offset:37472
    ds_read_b64_tr_b16 v[136:137], v6 offset:32
    ds_read_b64_tr_b16 v[138:139], v6 offset:4192
    ds_read_b64_tr_b16 v[140:141], v6 offset:33312
    ds_read_b64_tr_b16 v[142:143], v6 offset:37472
    s_waitcnt lgkmcnt(0)
    ds_read_b64_tr_b16 v[144:145], v5 offset:64
    ds_read_b64_tr_b16 v[146:147], v5 offset:4224
    ds_read_b64_tr_b16 v[148:149], v5 offset:33344
    ds_read_b64_tr_b16 v[150:151], v5 offset:37504
    ds_read_b64_tr_b16 v[152:153], v6 offset:64
    ds_read_b64_tr_b16 v[154:155], v6 offset:4224
    ds_read_b64_tr_b16 v[156:157], v6 offset:33344
    ds_read_b64_tr_b16 v[158:159], v6 offset:37504
    s_waitcnt lgkmcnt(0)
    ds_read_b64_tr_b16 v[160:161], v5 offset:96
    ds_read_b64_tr_b16 v[162:163], v5 offset:4256
    ds_read_b64_tr_b16 v[164:165], v5 offset:33376
    ds_read_b64_tr_b16 v[166:167], v5 offset:37536
    ds_read_b64_tr_b16 v[168:169], v6 offset:96
    ds_read_b64_tr_b16 v[170:171], v6 offset:4256
    ds_read_b64_tr_b16 v[172:173], v6 offset:33376
    ds_read_b64_tr_b16 v[174:175], v6 offset:37536
    s_waitcnt lgkmcnt(0)
    s_mul_i32 s52, s48, 2080
    s_add_u32 s52, s52, 12288
    v_add_u32 v28, s52, v41
    v_add_u32 v29, 12288, v43
    v_lshlrev_b32 v30, 5, v2
    v_mul_u32_u24 v32, 272, v2
    v_lshl_add_u32 v31, v3, 3, v32
    s_lshl_b32 s52, s48, 5
    v_add_u32 v31, s52, v31
    v_lshl_add_u32 v32, v3, 4, v32
    v_lshlrev_b32 v33, 12, v3
    v_lshl_add_u32 v33, v2, 3, v33
    s_lshl_b32 s95, s48, 2
    v_add_u32 v34, s95, v30
    v_lshlrev_b32 v35, 7, v2
    v_lshl_add_u32 v35, v3, 2, v35
    s_lshl_b32 s95, s48, 4
    v_add_u32 v35, s95, v35
    s_lshl_b32 s52, s57, 4
    s_lshl_b32 s53, s48, 1
    s_add_u32 s52, s52, s53
    s_lshl_b32 s54, s52, 10
    s_lshl_b32 s52, s52, 8
    s_add_u32 s52, s52, 65536
    s_and_b32 s53, s56, 7
    v_mul_u32_u24 v7, 2, v1
    v_add_u32 v7, s53, v7
    v_subrev_u32 v38, 8, v7
    v_min_u32 v7, v7, v38
    v_lshlrev_b32 v7, 6, v7
    s_waitcnt vmcnt(0)
    v_max3_u32 v8, v240, v241, v242
    v_max3_u32 v8, v8, v243, v244
    v_max3_u32 v8, v8, v245, v246
    v_max_u32 v8, v8, v247
    v_cmp_eq_u32 vcc, -1, v8
    s_cbranch_vccz L_qok_32
    s_mov_b64 s[60:61], 0xf
    s_mov_b32 s51, 0
L_poll_33:
    s_mov_b64 exec, s[60:61]
    buffer_load_dword v176, v7, s[44:47], s52 offen sc1
    s_mov_b64 exec, -1
    s_waitcnt vmcnt(0)
    v_cmp_eq_u32 s[76:77], -1, v176
    s_and_b64 s[60:61], s[60:61], s[76:77]
    s_cbranch_scc0 L_polld_34
    s_add_u32 s51, s51, 1
    s_cmp_gt_u32 s51, 200000
    s_cbranch_scc1 L_polld_34
    s_sleep 3
    s_branch L_poll_33
L_polld_34:
    s_mov_b64 s[60:61], -1
    s_mov_b64 s[62:63], -1
    s_mov_b32 s51, 0
L_poll_35:
    s_mov_b64 exec, s[60:61]
    buffer_load_dwordx4 v[240:243], v41, s[44:47], s54 offen offset:0 sc1
    s_mov_b64 exec, s[62:63]
    buffer_load_dwordx4 v[244:247], v41, s[44:47], s54 offen offset:1024 sc1
    s_mov_b64 exec, -1
    s_waitcnt vmcnt(0)
    v_max_u32 v39, v240, v241
    v_max3_u32 v39, v39, v242, v243
    v_cmp_eq_u32 s[76:77], -1, v39
    s_and_b64 s[60:61], s[60:61], s[76:77]
    v_max_u32 v39, v244, v245
    v_max3_u32 v39, v39, v246, v247
    v_cmp_eq_u32 s[76:77], -1, v39
    s_and_b64 s[62:63], s[62:63], s[76:77]
    s_or_b64 s[78:79], s[60:61], s[62:63]
    s_cbranch_scc0 L_polld_36
    s_add_u32 s51, s51, 1
    s_cmp_gt_u32 s51, 200000
    s_cbranch_scc1 L_polld_36
    s_sleep 1
    s_branch L_poll_35
L_polld_36:
L_qok_32:
    ds_write_b128 v28, v[240:243] offset:0
    ds_write_b128 v28, v[244:247] offset:1040
    s_waitcnt lgkmcnt(0)
    s_barrier
    s_cmp_lg_u32 s48, 7
    s_cbranch_scc1 L_mk_37
    s_lshl_b32 s52, s58, 7
    s_add_u32 s52, s52, 147456
    v_lshlrev_b32 v5, 3, v2
    v_mov_b32 v16, 0
    v_mov_b32 v17, -1.0
    s_mov_b32 exec_lo, 0xffff
    s_mov_b32 exec_hi, 0x0
    buffer_store_dwordx2 v[16:17], v5, s[44:47], s52 offen sc1
    s_mov_b64 exec, -1
    s_lshl_b32 s52, s58, 6
    s_add_u32 s52, s52, 614400
    v_mov_b32 v7, 1
    v_mov_b32 v38, 0
    s_mov_b32 exec_lo, 0x1
    s_mov_b32 exec_hi, 0x0
    buffer_store_dword v7, v38, s[44:47], s52 offen sc1
    s_mov_b64 exec, -1
L_mk_37:
    ds_read_b128 v[176:179], v29 offset:0
    ds_read_b128 v[180:183], v29 offset:64
    ds_read_b128 v[184:187], v29 offset:128
    ds_read_b128 v[188:191], v29 offset:192
    ds_read_b128 v[192:195], v29 offset:256
    ds_read_b128 v[196:199], v29 offset:320
    ds_read_b128 v[200:203], v29 offset:384
    ds_read_b128 v[204:207], v29 offset:448
    s_waitcnt lgkmcnt(7)
    v_mfma_f32_16x16x32_bf16 v[8:11], v[48:51], v[176:179], 0
    s_waitcnt lgkmcnt(6)
    v_mfma_f32_16x16x32_bf16 v[8:11], v[52:55], v[180:183], v[8:11]
    s_waitcnt lgkmcnt(5)
    v_mfma_f32_16x16x32_bf16 v[8:11], v[56:59], v[184:187], v[8:11]
    s_waitcnt lgkmcnt(4)
    v_mfma_f32_16x16x32_bf16 v[8:11], v[60:63], v[188:191], v[8:11]
    s_waitcnt lgkmcnt(3)
    v_mfma_f32_16x16x32_bf16 v[8:11], v[64:67], v[192:195], v[8:11]
    s_waitcnt lgkmcnt(2)
    v_mfma_f32_16x16x32_bf16 v[8:11], v[68:71], v[196:199], v[8:11]
    s_waitcnt lgkmcnt(1)
    v_mfma_f32_16x16x32_bf16 v[8:11], v[72:75], v[200:203], v[8:11]
    s_waitcnt lgkmcnt(0)
    v_mfma_f32_16x16x32_bf16 v[8:11], v[76:79], v[204:207], v[8:11]
    ds_read_b128 v[176:179], v29 offset:512
    ds_read_b128 v[180:183], v29 offset:576
    ds_read_b128 v[184:187], v29 offset:640
    ds_read_b128 v[188:191], v29 offset:704
    ds_read_b128 v[192:195], v29 offset:768
    ds_read_b128 v[196:199], v29 offset:832
    ds_read_b128 v[200:203], v29 offset:896
    ds_read_b128 v[204:207], v29 offset:960
    s_waitcnt lgkmcnt(7)
    v_mfma_f32_16x16x32_bf16 v[8:11], v[80:83], v[176:179], v[8:11]
    s_waitcnt lgkmcnt(6)
    v_mfma_f32_16x16x32_bf16 v[8:11], v[84:87], v[180:183], v[8:11]
    s_waitcnt lgkmcnt(5)
    v_mfma_f32_16x16x32_bf16 v[8:11], v[88:91], v[184:187], v[8:11]
    s_waitcnt lgkmcnt(4)
    v_mfma_f32_16x16x32_bf16 v[8:11], v[92:95], v[188:191], v[8:11]
    s_waitcnt lgkmcnt(3)
    v_mfma_f32_16x16x32_bf16 v[8:11], v[96:99], v[192:195], v[8:11]
    s_waitcnt lgkmcnt(2)
    v_mfma_f32_16x16x32_bf16 v[8:11], v[100:103], v[196:199], v[8:11]
    s_waitcnt lgkmcnt(1)
    v_mfma_f32_16x16x32_bf16 v[8:11], v[104:107], v[200:203], v[8:11]
    s_waitcnt lgkmcnt(0)
    v_mfma_f32_16x16x32_bf16 v[8:11], v[108:111], v[204:207], v[8:11]
    s_cmp_lg_u32 s48, 6
    s_cbranch_scc1 L_h1_38
    s_lshl_b32 s52, s58, 6
    s_add_u32 s52, s52, 614432
    v_mov_b32 v7, 1
    v_mov_b32 v38, 0
    s_mov_b32 exec_lo, 0x1
    s_mov_b32 exec_hi, 0x0
    buffer_store_dword v7, v38, s[44:47], s52 offen sc1
    s_mov_b64 exec, -1
L_h1_38:
    s_mov_b32 s52, 0x3db504f3
    v_cvt_pk_bf16_f32 v12, v8, v9
    v_cvt_pk_bf16_f32 v13, v10, v11
    v_lshlrev_b32 v8, 16, v12
    v_and_b32 v9, 0xffff0000, v12
    v_lshlrev_b32 v10, 16, v13
    v_and_b32 v11, 0xffff0000, v13
    v_mul_f32 v8, s52, v8
    v_mul_f32 v9, s52, v9
    v_mul_f32 v10, s52, v10
    v_mul_f32 v11, s52, v11
    v_cvt_pk_bf16_f32 v12, v8, v9
    v_cvt_pk_bf16_f32 v13, v10, v11
    v_lshlrev_b32 v8, 16, v12
    v_and_b32 v9, 0xffff0000, v12
    v_lshlrev_b32 v10, 16, v13
    v_and_b32 v11, 0xffff0000, v13
    v_max3_f32 v12, v8, v9, v10
    v_max_f32 v12, v12, v11
    v_mov_b32 v13, v12
    s_nop 1
    v_permlane32_swap_b32 v12, v13
    v_max_f32 v12, v12, v13
    v_mov_b32 v13, v12
    s_nop 1
    v_permlane16_swap_b32 v12, v13
    v_max_f32 v12, v12, v13
    ds_write_b32 v34, v12 offset:4096
    s_waitcnt lgkmcnt(0)
    s_barrier
    ds_read_b128 v[16:19], v30 offset:4096
    ds_read_b128 v[20:23], v30 offset:4112
    s_waitcnt lgkmcnt(0)
    v_max3_f32 v12, v16, v17, v18
    v_max3_f32 v13, v19, v20, v21
    v_max3_f32 v12, v12, v22, v23
    v_max_f32 v12, v12, v13
    v_mul_f32 v14, s94, v12
    v_fma_f32 v8, v8, s94, -v14
    v_fma_f32 v9, v9, s94, -v14
    v_fma_f32 v10, v10, s94, -v14
    v_fma_f32 v11, v11, s94, -v14
    v_exp_f32 v8, v8
    v_exp_f32 v9, v9
    v_exp_f32 v10, v10
    v_exp_f32 v11, v11
    v_cvt_pk_bf16_f32 v16, v8, v9
    v_cvt_pk_bf16_f32 v17, v10, v11
    ds_write_b64 v31, v[16:17] offset:6656
    v_add_f32 v8, v8, v9
    v_add_f32 v10, v10, v11
    v_add_f32 v8, v8, v10
    ds_write_b32 v35, v8 offset:4608
    s_waitcnt lgkmcnt(0)
    s_barrier
    ds_read_b128 v[224:227], v32 offset:6656
    ds_read_b128 v[228:231], v32 offset:6720
    ds_read_b128 v[232:235], v32 offset:6784
    ds_read_b128 v[236:239], v32 offset:6848
    s_cmp_lg_u32 s48, 7
    s_cbranch_scc1 L_st_39
    v_lshlrev_b32 v5, 7, v2
    v_lshl_add_u32 v5, v3, 5, v5
    ds_read_b128 v[16:19], v5 offset:4608
    ds_read_b128 v[20:23], v5 offset:4624
    s_lshl_b32 s52, s58, 7
    s_add_u32 s52, s52, 147456
    v_lshlrev_b32 v5, 3, v2
    s_waitcnt lgkmcnt(0)
    v_add_f32 v16, v16, v20
    v_add_f32 v17, v17, v21
    v_add_f32 v18, v18, v22
    v_add_f32 v19, v19, v23
    v_add_f32 v16, v16, v18
    v_add_f32 v17, v17, v19
    v_add_f32 v16, v16, v17
    v_mov_b32 v17, v16
    s_nop 1
    v_permlane32_swap_b32 v16, v17
    v_add_f32 v16, v16, v17
    v_mov_b32 v17, v16
    s_nop 1
    v_permlane16_swap_b32 v16, v17
    v_add_f32 v16, v16, v17
    v_min_u32 v12, -2, v12
    v_and_b32 v13, 0x7fffffff, v16
    s_mov_b32 exec_lo, 0xffff
    s_mov_b32 exec_hi, 0x0
    buffer_store_dwordx2 v[12:13], v5, s[44:47], s52 offen sc1
    s_mov_b64 exec, -1
L_st_39:
    s_lshl_b32 s52, s58, 14
    s_lshl_b32 s53, s48, 7
    s_add_u32 s52, s52, s53
    s_add_u32 s52, s52, 1048576
    s_waitcnt lgkmcnt(3)
    v_mfma_f32_16x16x32_bf16 v[208:211], v[224:227], v[112:115], 0
    v_mfma_f32_16x16x32_bf16 v[212:215], v[224:227], v[128:131], 0
    v_mfma_f32_16x16x32_bf16 v[216:219], v[224:227], v[144:147], 0
    v_mfma_f32_16x16x32_bf16 v[220:223], v[224:227], v[160:163], 0
    s_waitcnt lgkmcnt(2)
    v_mfma_f32_16x16x32_bf16 v[208:211], v[228:231], v[116:119], v[208:211]
    v_mfma_f32_16x16x32_bf16 v[212:215], v[228:231], v[132:135], v[212:215]
    v_mfma_f32_16x16x32_bf16 v[216:219], v[228:231], v[148:151], v[216:219]
    v_mfma_f32_16x16x32_bf16 v[220:223], v[228:231], v[164:167], v[220:223]
    s_waitcnt lgkmcnt(1)
    v_mfma_f32_16x16x32_bf16 v[208:211], v[232:235], v[120:123], v[208:211]
    v_mfma_f32_16x16x32_bf16 v[212:215], v[232:235], v[136:139], v[212:215]
    v_mfma_f32_16x16x32_bf16 v[216:219], v[232:235], v[152:155], v[216:219]
    v_mfma_f32_16x16x32_bf16 v[220:223], v[232:235], v[168:171], v[220:223]
    s_waitcnt lgkmcnt(0)
    v_mfma_f32_16x16x32_bf16 v[208:211], v[236:239], v[124:127], v[208:211]
    v_mfma_f32_16x16x32_bf16 v[212:215], v[236:239], v[140:143], v[212:215]
    v_mfma_f32_16x16x32_bf16 v[216:219], v[236:239], v[156:159], v[216:219]
    v_mfma_f32_16x16x32_bf16 v[220:223], v[236:239], v[172:175], v[220:223]
    s_nop 5
    v_cvt_pk_bf16_f32 v16, v208, v212
    s_nop 0
    v_cvt_pk_bf16_f32 v17, v216, v220
    v_min_u32 v16, -2, v16
    v_min_u32 v17, -2, v17
    buffer_store_dwordx2 v[16:17], v33, s[44:47], s52 offen offset:0 sc1
    v_cvt_pk_bf16_f32 v18, v209, v213
    v_cvt_pk_bf16_f32 v19, v217, v221
    v_min_u32 v18, -2, v18
    v_min_u32 v19, -2, v19
    buffer_store_dwordx2 v[18:19], v33, s[44:47], s52 offen offset:1024 sc1
    v_cvt_pk_bf16_f32 v20, v210, v214
    v_cvt_pk_bf16_f32 v21, v218, v222
    v_min_u32 v20, -2, v20
    v_min_u32 v21, -2, v21
    buffer_store_dwordx2 v[20:21], v33, s[44:47], s52 offen offset:2048 sc1
    v_cvt_pk_bf16_f32 v22, v211, v215
    v_cvt_pk_bf16_f32 v23, v219, v223
    v_min_u32 v22, -2, v22
    v_min_u32 v23, -2, v23
    buffer_store_dwordx2 v[22:23], v33, s[44:47], s52 offen offset:3072 sc1
    s_cmp_eq_u32 s88, 0
    s_cbranch_scc1 L_fin
    s_barrier
    v_lshrrev_b32 v4, 2, v1
    v_mul_u32_u24 v4, 3456, v4
    v_and_b32 v5, 3, v1
    v_lshl_add_u32 v4, v5, 4, v4
    s_mul_i32 s52, s48, 276480
    s_lshl_b32 s53, s59, 6
    s_add_u32 s52, s52, s53
    s_mul_i32 s54, s48, 5120
    s_mul_i32 s53, s59, 40960
    s_add_u32 s53, s53, s54
    s_add_u32 s55, s54, 55296
    s_add_u32 s54, s54, 12288
    s_mov_b32 m0, s54
    s_nop 0
    buffer_load_dwordx4 v4, s[28:31], s52 offen nt lds
    s_mov_b32 m0, s55
    s_nop 0
    buffer_load_dwordx4 v41, s[32:35], s53 offen nt lds
    s_add_u32 s52, s52, 55296
    s_add_u32 s54, s54, 1024
    s_add_u32 s53, s53, 1024
    s_add_u32 s55, s55, 1024
    s_mov_b32 m0, s54
    s_nop 0
    buffer_load_dwordx4 v4, s[28:31], s52 offen nt lds
    s_mov_b32 m0, s55
    s_nop 0
    buffer_load_dwordx4 v41, s[32:35], s53 offen nt lds
    s_add_u32 s52, s52, 55296
    s_add_u32 s54, s54, 1024
    s_add_u32 s53, s53, 1024
    s_add_u32 s55, s55, 1024
    s_mov_b32 m0, s54
    s_nop 0
    buffer_load_dwordx4 v4, s[28:31], s52 offen nt lds
    s_mov_b32 m0, s55
    s_nop 0
    buffer_load_dwordx4 v41, s[32:35], s53 offen nt lds
    s_add_u32 s52, s52, 55296
    s_add_u32 s54, s54, 1024
    s_add_u32 s53, s53, 1024
    s_add_u32 s55, s55, 1024
    s_mov_b32 m0, s54
    s_nop 0
    buffer_load_dwordx4 v4, s[28:31], s52 offen nt lds
    s_mov_b32 m0, s55
    s_nop 0
    buffer_load_dwordx4 v41, s[32:35], s53 offen nt lds
    s_add_u32 s52, s52, 55296
    s_add_u32 s54, s54, 1024
    s_add_u32 s53, s53, 1024
    s_add_u32 s55, s55, 1024
    s_mov_b32 m0, s54
    s_nop 0
    buffer_load_dwordx4 v4, s[28:31], s52 offen nt lds
    s_mov_b32 m0, s55
    s_nop 0
    buffer_load_dwordx4 v41, s[32:35], s53 offen nt lds
    v_lshlrev_b32 v4, 2, v0
    s_cmp_ge_u32 s48, 5
    s_cbranch_scc1 L_w2_40
    buffer_load_dword v112, v4, s[4:7], 0 offen
    v_mov_b32 v5, 0x3f803f80
    ds_write_b32 v4, v5 offset:5376
L_w2_40:
    s_cmp_lg_u32 s48, 7
    s_cbranch_scc1 L_oh_41
    v_lshlrev_b32 v5, 8, v1
    s_xor_b32 s52, s57, 1
    s_lshl_b32 s52, s52, 14
    s_mov_b64 s[60:61], -1
    s_mov_b32 s51, 0
L_poll_42:
    s_mov_b64 exec, s[60:61]
    buffer_load_dword v116, v5, s[44:47], s52 offen sc1
    s_mov_b64 exec, -1
    s_waitcnt vmcnt(0)
    v_cmp_eq_u32 s[76:77], -1, v116
    s_and_b64 s[60:61], s[60:61], s[76:77]
    s_cbranch_scc0 L_polld_43
    s_add_u32 s51, s51, 1
    s_cmp_gt_u32 s51, 200000
    s_cbranch_scc1 L_polld_43
    s_sleep 8
    s_branch L_poll_42
L_polld_43:
L_oh_41:
    s_waitcnt vmcnt(0) lgkmcnt(0)
    s_barrier
    s_cmp_ge_u32 s48, 5
    s_cbranch_scc1 L_p5_44
    v_add_u32 v5, 55296, v4
    ds_read_b32 v48, v5 offset:0
    ds_read_b32 v49, v5 offset:1280
    ds_read_b32 v50, v5 offset:2560
    ds_read_b32 v51, v5 offset:3840
    ds_read_b32 v52, v5 offset:5120
    ds_read_b32 v53, v5 offset:6400
    ds_read_b32 v54, v5 offset:7680
    ds_read_b32 v55, v5 offset:8960
    s_waitcnt lgkmcnt(0)
    ds_read_b32 v56, v5 offset:10240
    ds_read_b32 v57, v5 offset:11520
    ds_read_b32 v58, v5 offset:12800
    ds_read_b32 v59, v5 offset:14080
    ds_read_b32 v60, v5 offset:15360
    ds_read_b32 v61, v5 offset:16640
    ds_read_b32 v62, v5 offset:17920
    ds_read_b32 v63, v5 offset:19200
    s_waitcnt lgkmcnt(0)
    ds_read_b32 v64, v5 offset:20480
    ds_read_b32 v65, v5 offset:21760
    ds_read_b32 v66, v5 offset:23040
    ds_read_b32 v67, v5 offset:24320
    ds_read_b32 v68, v5 offset:25600
    ds_read_b32 v69, v5 offset:26880
    ds_read_b32 v70, v5 offset:28160
    ds_read_b32 v71, v5 offset:29440
    s_waitcnt lgkmcnt(0)
    ds_read_b32 v72, v5 offset:30720
    ds_read_b32 v73, v5 offset:32000
    ds_read_b32 v74, v5 offset:33280
    ds_read_b32 v75, v5 offset:34560
    ds_read_b32 v76, v5 offset:35840
    ds_read_b32 v77, v5 offset:37120
    ds_read_b32 v78, v5 offset:38400
    ds_read_b32 v79, v5 offset:39680
    s_waitcnt lgkmcnt(0)
    s_mov_b32 s52, 0x05040100
    s_mov_b32 s53, 0x07060302
    v_perm_b32 v80, v49, v48, s52
    v_perm_b32 v81, v49, v48, s53
    v_perm_b32 v82, v51, v50, s52
    v_perm_b32 v83, v51, v50, s53
    v_perm_b32 v84, v53, v52, s52
    v_perm_b32 v85, v53, v52, s53
    v_perm_b32 v86, v55, v54, s52
    v_perm_b32 v87, v55, v54, s53
    v_perm_b32 v88, v57, v56, s52
    v_perm_b32 v89, v57, v56, s53
    v_perm_b32 v90, v59, v58, s52
    v_perm_b32 v91, v59, v58, s53
    v_perm_b32 v92, v61, v60, s52
    v_perm_b32 v93, v61, v60, s53
    v_perm_b32 v94, v63, v62, s52
    v_perm_b32 v95, v63, v62, s53
    v_perm_b32 v96, v65, v64, s52
    v_perm_b32 v97, v65, v64, s53
    v_perm_b32 v98, v67, v66, s52
    v_perm_b32 v99, v67, v66, s53
    v_perm_b32 v100, v69, v68, s52
    v_perm_b32 v101, v69, v68, s53
    v_perm_b32 v102, v71, v70, s52
    v_perm_b32 v103, v71, v70, s53
    v_perm_b32 v104, v73, v72, s52
    v_perm_b32 v105, v73, v72, s53
    v_perm_b32 v106, v75, v74, s52
    v_perm_b32 v107, v75, v74, s53
    v_perm_b32 v108, v77, v76, s52
    v_perm_b32 v109, v77, v76, s53
    v_perm_b32 v110, v79, v78, s52
    v_perm_b32 v111, v79, v78, s53
    v_and_b32 v113, 0xffff0000, v112
    v_lshlrev_b32 v112, 16, v112
    v_mov_b32 v114, 0x3f80
    v_mov_b32 v115, 1.0
    s_branch L_pd_45
L_p5_44:
    v_lshrrev_b32 v5, 2, v2
    v_lshl_add_u32 v5, v3, 3, v5
    v_lshlrev_b32 v5, 6, v5
    v_and_b32 v6, 3, v2
    v_lshl_add_u32 v5, v6, 3, v5
    s_sub_u32 s52, s48, 5
    s_mul_i32 s53, s52, 14336
    v_add_u32 v5, s53, v5
    ds_read_b64_tr_b16 v[48:49], v5 offset:12288
    ds_read_b64_tr_b16 v[50:51], v5 offset:12544
    ds_read_b64_tr_b16 v[52:53], v5 offset:12320
    ds_read_b64_tr_b16 v[54:55], v5 offset:12576
    ds_read_b64_tr_b16 v[56:57], v5 offset:14336
    ds_read_b64_tr_b16 v[58:59], v5 offset:14592
    ds_read_b64_tr_b16 v[60:61], v5 offset:14368
    ds_read_b64_tr_b16 v[62:63], v5 offset:14624
    s_waitcnt lgkmcnt(0)
    ds_read_b64_tr_b16 v[64:65], v5 offset:16384
    ds_read_b64_tr_b16 v[66:67], v5 offset:16640
    ds_read_b64_tr_b16 v[68:69], v5 offset:16416
    ds_read_b64_tr_b16 v[70:71], v5 offset:16672
    ds_read_b64_tr_b16 v[72:73], v5 offset:18432
    ds_read_b64_tr_b16 v[74:75], v5 offset:18688
    ds_read_b64_tr_b16 v[76:77], v5 offset:18464
    ds_read_b64_tr_b16 v[78:79], v5 offset:18720
    s_waitcnt lgkmcnt(0)
    ds_read_b64_tr_b16 v[80:81], v5 offset:20480
    ds_read_b64_tr_b16 v[82:83], v5 offset:20736
    ds_read_b64_tr_b16 v[84:85], v5 offset:20512
    ds_read_b64_tr_b16 v[86:87], v5 offset:20768
    ds_read_b64_tr_b16 v[88:89], v5 offset:22528
    ds_read_b64_tr_b16 v[90:91], v5 offset:22784
    ds_read_b64_tr_b16 v[92:93], v5 offset:22560
    ds_read_b64_tr_b16 v[94:95], v5 offset:22816
    s_waitcnt lgkmcnt(0)
    ds_read_b64_tr_b16 v[96:97], v5 offset:24576
    ds_read_b64_tr_b16 v[98:99], v5 offset:24832
    ds_read_b64_tr_b16 v[100:101], v5 offset:24608
    ds_read_b64_tr_b16 v[102:103], v5 offset:24864
    v_lshlrev_b32 v6, 4, v3
    s_mul_i32 s53, s52, 448
    v_add_u32 v6, s53, v6
    v_add_u32 v7, 1280, v6
    v_cmp_eq_u32 vcc, 1, v2
    s_nop 1
    v_cndmask_b32 v6, v6, v7, vcc
    s_waitcnt lgkmcnt(0)
L_pd_45:
    s_cmp_ge_u32 s48, 5
    s_cbranch_scc1 L_dh_46
    s_lshl_b32 s52, s59, 1
    v_mul_u32_u24 v7, 29, v1
    v_add_u32 v7, s52, v7
    v_subrev_u32 v38, 120, v7
    v_min_u32 v7, v7, v38
    v_lshlrev_b32 v7, 6, v7
    s_mov_b32 s52, 647168
    s_mov_b64 s[60:61], 0xf
    s_mov_b32 s51, 0
L_poll_47:
    s_mov_b64 exec, s[60:61]
    buffer_load_dword v116, v7, s[44:47], s52 offen sc1
    s_mov_b64 exec, -1
    s_waitcnt vmcnt(0)
    v_cmp_eq_u32 s[76:77], -1, v116
    s_and_b64 s[60:61], s[60:61], s[76:77]
    s_cbranch_scc0 L_polld_48
    s_add_u32 s51, s51, 1
    s_cmp_gt_u32 s51, 200000
    s_cbranch_scc1 L_polld_48
    s_sleep 4
    s_branch L_poll_47
L_polld_48:
    v_lshlrev_b32 v5, 3, v0
    s_mov_b32 s80, 589824
    s_mov_b32 s81, 594944
    s_mov_b32 s82, 600064
    v_mov_b32 v140, 0
    v_mov_b32 v141, 0
    s_mov_b64 s[60:61], -1
    s_mov_b64 s[62:63], -1
    s_mov_b64 s[64:65], -1
    s_mov_b32 s51, 0
L_poll_49:
    s_mov_b64 exec, s[60:61]
    buffer_load_dword v116, v4, s[44:47], s80 offen offset:0 sc1
    buffer_load_dword v117, v4, s[44:47], s80 offen offset:1280 sc1
    buffer_load_dword v118, v4, s[44:47], s80 offen offset:2560 sc1
    buffer_load_dword v119, v4, s[44:47], s80 offen offset:3840 sc1
    s_mov_b64 exec, s[62:63]
    buffer_load_dword v120, v4, s[44:47], s81 offen offset:0 sc1
    buffer_load_dword v121, v4, s[44:47], s81 offen offset:1280 sc1
    buffer_load_dword v122, v4, s[44:47], s81 offen offset:2560 sc1
    buffer_load_dword v123, v4, s[44:47], s81 offen offset:3840 sc1
    s_mov_b64 exec, s[64:65]
    buffer_load_dword v124, v4, s[44:47], s82 offen offset:0 sc1
    buffer_load_dword v125, v4, s[44:47], s82 offen offset:1280 sc1
    buffer_load_dword v126, v4, s[44:47], s82 offen offset:2560 sc1
    buffer_load_dword v127, v4, s[44:47], s82 offen offset:3840 sc1
    s_mov_b64 exec, -1
    s_waitcnt vmcnt(0)
    v_max_u32 v39, v116, v117
    v_max3_u32 v39, v39, v118, v119
    v_cmp_eq_u32 s[76:77], -1, v39
    s_and_b64 s[60:61], s[60:61], s[76:77]
    v_max_u32 v39, v120, v121
    v_max3_u32 v39, v39, v122, v123
    v_cmp_eq_u32 s[76:77], -1, v39
    s_and_b64 s[62:63], s[62:63], s[76:77]
    s_or_b64 s[78:79], s[60:61], s[62:63]
    v_max_u32 v39, v124, v125
    v_max3_u32 v39, v39, v126, v127
    v_cmp_eq_u32 s[76:77], -1, v39
    s_and_b64 s[64:65], s[64:65], s[76:77]
    s_or_b64 s[78:79], s[78:79], s[64:65]
    s_cbranch_scc0 L_polld_50
    s_add_u32 s51, s51, 1
    s_cmp_gt_u32 s51, 200000
    s_cbranch_scc1 L_polld_50
    s_sleep 1
    s_branch L_poll_49
L_polld_50:
    v_dot2c_f32_bf16 v140, v116, v114
    v_dot2c_f32_bf16 v141, v116, v115
    v_dot2c_f32_bf16 v140, v117, v114
    v_dot2c_f32_bf16 v141, v117, v115
    v_dot2c_f32_bf16 v140, v118, v114
    v_dot2c_f32_bf16 v141, v118, v115
    v_dot2c_f32_bf16 v140, v119, v114
    v_dot2c_f32_bf16 v141, v119, v115
    v_dot2c_f32_bf16 v140, v120, v114
    v_dot2c_f32_bf16 v141, v120, v115
    v_dot2c_f32_bf16 v140, v121, v114
    v_dot2c_f32_bf16 v141, v121, v115
    v_dot2c_f32_bf16 v140, v122, v114
    v_dot2c_f32_bf16 v141, v122, v115
    v_dot2c_f32_bf16 v140, v123, v114
    v_dot2c_f32_bf16 v141, v123, v115
    v_dot2c_f32_bf16 v140, v124, v114
    v_dot2c_f32_bf16 v141, v124, v115
    v_dot2c_f32_bf16 v140, v125, v114
    v_dot2c_f32_bf16 v141, v125, v115
    v_dot2c_f32_bf16 v140, v126, v114
    v_dot2c_f32_bf16 v141, v126, v115
    v_dot2c_f32_bf16 v140, v127, v114
    v_dot2c_f32_bf16 v141, v127, v115
    s_nop 2
    v_cvt_pk_bf16_f32 v8, v140, v141
    v_lshlrev_b32 v140, 16, v8
    v_and_b32 v141, 0xffff0000, v8
    v_pk_add_f32 v[140:141], v[140:141], v[112:113]
    v_cvt_pk_bf16_f32 v8, v140, v141
    ds_write_b32 v4, v8 offset:4096
    v_lshlrev_b32 v140, 16, v8
    v_and_b32 v141, 0xffff0000, v8
    s_waitcnt lgkmcnt(0)
L_dh_46:
    s_barrier
    s_cmp_ge_u32 s48, 5
    s_cbranch_scc1 L_dm_51
    ds_write_b64 v5, v[140:141] offset:7168
    v_add_f32 v8, v140, v141
    s_nop 1
    v_add_f32_dpp v8, v8, v8 row_shr:1 row_mask:0xf bank_mask:0xf bound_ctrl:0
    s_nop 1
    v_add_f32_dpp v8, v8, v8 row_shr:2 row_mask:0xf bank_mask:0xf bound_ctrl:0
    s_nop 1
    v_add_f32_dpp v8, v8, v8 row_shr:4 row_mask:0xf bank_mask:0xf bound_ctrl:0
    s_nop 1
    v_add_f32_dpp v8, v8, v8 row_shr:8 row_mask:0xf bank_mask:0xf bound_ctrl:0
    s_nop 1
    v_add_f32_dpp v8, v8, v8 row_bcast:15 row_mask:0xa bank_mask:0xf
    s_nop 1
    v_add_f32_dpp v8, v8, v8 row_bcast:31 row_mask:0xc bank_mask:0xf
    s_nop 0
    v_readlane_b32 s52, v8, 63
    s_nop 1
    v_mov_b32 v10, s52
    v_mul_f32 v10, 0x3c000000, v10
    v_sub_f32 v8, v140, v10
    v_sub_f32 v9, v141, v10
    v_mul_f32 v8, v8, v8
    v_fmac_f32 v8, v9, v9
    s_nop 1
    v_add_f32_dpp v8, v8, v8 row_shr:1 row_mask:0xf bank_mask:0xf bound_ctrl:0
    s_nop 1
    v_add_f32_dpp v8, v8, v8 row_shr:2 row_mask:0xf bank_mask:0xf bound_ctrl:0
    s_nop 1
    v_add_f32_dpp v8, v8, v8 row_shr:4 row_mask:0xf bank_mask:0xf bound_ctrl:0
    s_nop 1
    v_add_f32_dpp v8, v8, v8 row_shr:8 row_mask:0xf bank_mask:0xf bound_ctrl:0
    s_nop 1
    v_add_f32_dpp v8, v8, v8 row_bcast:15 row_mask:0xa bank_mask:0xf
    s_nop 1
    v_add_f32_dpp v8, v8, v8 row_bcast:31 row_mask:0xc bank_mask:0xf
    s_nop 0
    v_readlane_b32 s52, v8, 63
    s_nop 1
    v_mov_b32 v11, s52
    s_lshl_b32 s52, s48, 3
    v_mov_b32 v12, s52
    s_mov_b32 exec_lo, 0x1
    s_mov_b32 exec_hi, 0x0
    ds_write_b64 v12, v[10:11] offset:6656
    s_mov_b64 exec, -1
    s_branch L_dj_52
L_dm_51:
    ds_read_b128 v[116:119], v6 offset:4096
    ds_read_b128 v[120:123], v6 offset:4160
    ds_read_b128 v[124:127], v6 offset:4224
    ds_read_b128 v[128:131], v6 offset:4288
    ds_read_b128 v[132:135], v6 offset:4352
    ds_read_b128 v[136:139], v6 offset:4416
    ds_read_b128 v[140:143], v6 offset:4480
    s_waitcnt lgkmcnt(6)
    v_mfma_f32_16x16x32_bf16 v[8:11], v[116:119], v[48:51], 0
    v_mfma_f32_16x16x32_bf16 v[12:15], v[116:119], v[52:55], 0
    s_waitcnt lgkmcnt(5)
    v_mfma_f32_16x16x32_bf16 v[8:11], v[120:123], v[56:59], v[8:11]
    v_mfma_f32_16x16x32_bf16 v[12:15], v[120:123], v[60:63], v[12:15]
    s_waitcnt lgkmcnt(4)
    v_mfma_f32_16x16x32_bf16 v[8:11], v[124:127], v[64:67], v[8:11]
    v_mfma_f32_16x16x32_bf16 v[12:15], v[124:127], v[68:71], v[12:15]
    s_waitcnt lgkmcnt(3)
    v_mfma_f32_16x16x32_bf16 v[8:11], v[128:131], v[72:75], v[8:11]
    v_mfma_f32_16x16x32_bf16 v[12:15], v[128:131], v[76:79], v[12:15]
    s_waitcnt lgkmcnt(2)
    v_mfma_f32_16x16x32_bf16 v[8:11], v[132:135], v[80:83], v[8:11]
    v_mfma_f32_16x16x32_bf16 v[12:15], v[132:135], v[84:87], v[12:15]
    s_waitcnt lgkmcnt(1)
    v_mfma_f32_16x16x32_bf16 v[8:11], v[136:139], v[88:91], v[8:11]
    v_mfma_f32_16x16x32_bf16 v[12:15], v[136:139], v[92:95], v[12:15]
    s_cmp_eq_u32 s48, 7
    s_cbranch_scc1 L_z_53
    s_waitcnt lgkmcnt(0)
    v_mfma_f32_16x16x32_bf16 v[8:11], v[140:143], v[96:99], v[8:11]
    v_mfma_f32_16x16x32_bf16 v[12:15], v[140:143], v[100:103], v[12:15]
L_z_53:
    v_lshlrev_b32 v5, 3, v2
    s_sub_u32 s52, s48, 5
    s_lshl_b32 s52, s52, 8
    v_add_u32 v5, s52, v5
    s_mov_b32 exec_lo, 0xffff
    s_mov_b32 exec_hi, 0x0
    s_nop 2
    ds_write_b64 v5, v[8:9] offset:0
    ds_write_b64 v5, v[12:13] offset:128
    s_mov_b64 exec, -1
L_dj_52:
    s_waitcnt lgkmcnt(0)
    s_barrier
    s_cmp_ge_u32 s48, 5
    s_cbranch_scc1 L_d2_54
    v_mov_b32 v6, 0
    v_and_b32 v7, 31, v1
    v_lshlrev_b32 v7, 3, v7
    ds_read_b128 v[16:19], v6 offset:6656
    ds_read_b128 v[20:23], v6 offset:6672
    ds_read_b64 v[24:25], v6 offset:6688
    ds_read_b64 v[28:29], v7 offset:0
    ds_read_b64 v[30:31], v7 offset:256
    ds_read_b64 v[32:33], v7 offset:512
    s_waitcnt lgkmcnt(3)
    v_pk_add_f32 v[8:9], v[16:17], v[18:19]
    v_pk_add_f32 v[10:11], v[20:21], v[22:23]
    v_pk_add_f32 v[8:9], v[8:9], v[24:25]
    v_pk_add_f32 v[8:9], v[8:9], v[10:11]
    v_mul_f32 v8, 0x3e4ccccd, v8
    v_mov_b32 v10, 0
    v_sub_f32 v11, v16, v8
    v_fmac_f32 v10, v11, v11
    v_sub_f32 v11, v18, v8
    v_fmac_f32 v10, v11, v11
    v_sub_f32 v11, v20, v8
    v_fmac_f32 v10, v11, v11
    v_sub_f32 v11, v22, v8
    v_fmac_f32 v10, v11, v11
    v_sub_f32 v11, v24, v8
    v_fmac_f32 v10, v11, v11
    v_fmac_f32 v9, 0x43000000, v10
    v_mul_f32 v9, 0x3acccccd, v9
    v_cvt_pk_bf16_f32 v8, v8, v8
    v_lshlrev_b32 v8, 16, v8
    v_cvt_pk_bf16_f32 v9, v9, v9
    v_lshlrev_b32 v9, 16, v9
    v_add_f32 v9, 0x3727c5ac, v9
    v_cvt_pk_bf16_f32 v9, v9, v9
    v_lshlrev_b32 v9, 16, v9
    v_sqrt_f32 v9, v9
    s_nop 0
    v_cvt_pk_bf16_f32 v9, v9, v9
    v_lshlrev_b32 v9, 16, v9
    v_rcp_f32 v9, v9
    s_waitcnt lgkmcnt(0)
    v_pk_add_f32 v[28:29], v[28:29], v[30:31]
    v_pk_add_f32 v[28:29], v[28:29], v[32:33]
    v_fma_f32 v28, -v8, v29, v28
    v_mul_f32 v28, v28, v9
    v_max_f32 v28, 0, v28
    s_nop 1
    v_mov_b32_dpp v29, v28 row_shl:1 row_mask:0xf bank_mask:0xf bound_ctrl:0
    v_cvt_pk_bf16_f32 v28, v28, v29
    s_nop 0
    v_readlane_b32 s60, v28, 0
    v_readlane_b32 s61, v28, 2
    v_readlane_b32 s62, v28, 4
    v_readlane_b32 s63, v28, 6
    v_readlane_b32 s64, v28, 8
    v_readlane_b32 s65, v28, 10
    v_readlane_b32 s66, v28, 12
    v_readlane_b32 s67, v28, 14
    v_readlane_b32 s68, v28, 16
    v_readlane_b32 s69, v28, 18
    v_readlane_b32 s70, v28, 20
    v_readlane_b32 s71, v28, 22
    v_readlane_b32 s72, v28, 24
    v_readlane_b32 s73, v28, 26
    v_readlane_b32 s74, v28, 28
    v_readlane_b32 s75, v28, 30
    v_mov_b32 v10, 0
    v_mov_b32 v11, 0
    v_mov_b32 v12, 0
    v_mov_b32 v13, 0
    v_dot2c_f32_bf16 v10, s60, v80
    v_dot2c_f32_bf16 v11, s60, v81
    v_dot2c_f32_bf16 v12, s61, v82
    v_dot2c_f32_bf16 v13, s61, v83
    v_dot2c_f32_bf16 v10, s62, v84
    v_dot2c_f32_bf16 v11, s62, v85
    v_dot2c_f32_bf16 v12, s63, v86
    v_dot2c_f32_bf16 v13, s63, v87
    v_dot2c_f32_bf16 v10, s64, v88
    v_dot2c_f32_bf16 v11, s64, v89
    v_dot2c_f32_bf16 v12, s65, v90
    v_dot2c_f32_bf16 v13, s65, v91
    v_dot2c_f32_bf16 v10, s66, v92
    v_dot2c_f32_bf16 v11, s66, v93
    v_dot2c_f32_bf16 v12, s67, v94
    v_dot2c_f32_bf16 v13, s67, v95
    v_dot2c_f32_bf16 v10, s68, v96
    v_dot2c_f32_bf16 v11, s68, v97
    v_dot2c_f32_bf16 v12, s69, v98
    v_dot2c_f32_bf16 v13, s69, v99
    v_dot2c_f32_bf16 v10, s70, v100
    v_dot2c_f32_bf16 v11, s70, v101
    v_dot2c_f32_bf16 v12, s71, v102
    v_dot2c_f32_bf16 v13, s71, v103
    v_dot2c_f32_bf16 v10, s72, v104
    v_dot2c_f32_bf16 v11, s72, v105
    v_dot2c_f32_bf16 v12, s73, v106
    v_dot2c_f32_bf16 v13, s73, v107
    v_dot2c_f32_bf16 v10, s74, v108
    v_dot2c_f32_bf16 v11, s74, v109
    v_dot2c_f32_bf16 v12, s75, v110
    v_dot2c_f32_bf16 v13, s75, v111
    s_mul_i32 s52, s59, 2560
    s_add_u32 s52, s52, 196608
    s_nop 0
    v_pk_add_f32 v[10:11], v[10:11], v[12:13]
    v_min_u32 v10, -2, v10
    v_min_u32 v11, -2, v11
    buffer_store_dwordx2 v[10:11], v5, s[44:47], s52 offen sc1
L_d2_54:
    s_cmp_eq_u32 s89, 0
    s_cbranch_scc1 L_fin
    v_lshrrev_b32 v5, 3, v1
    v_mul_u32_u24 v4, 2560, v5
    v_and_b32 v7, 7, v1
    v_lshl_add_u32 v4, v7, 4, v4
    s_mul_i32 s52, s48, 20480
    s_lshl_b32 s53, s59, 6
    s_add_u32 s52, s52, s53
    s_add_u32 s52, s52, 196608
    s_lshl_b32 s55, s48, 3
    v_add_u32 v5, s55, v5
    v_mov_b32 v144, 0
    v_mov_b32 v145, 0
    v_mov_b32 v146, 0
    v_mov_b32 v147, 0
    v_cmp_gt_u32 vcc, 54, v5
    s_mov_b64 s[90:91], vcc
    v_lshlrev_b32 v5, 4, v7
    v_lshl_add_u32 v5, v3, 2, v5
    s_lshl_b32 s55, s48, 7
    v_add_u32 v5, s55, v5
    s_sleep 4
    s_mov_b64 s[60:61], s[90:91]
    s_mov_b32 s51, 0
L_poll_55:
    s_mov_b64 exec, s[60:61]
    buffer_load_dwordx4 v[144:147], v4, s[44:47], s52 offen sc1
    s_mov_b64 exec, -1
    s_waitcnt vmcnt(0)
    v_max_u32 v39, v144, v145
    v_max3_u32 v39, v39, v146, v147
    v_cmp_eq_u32 s[76:77], -1, v39
    s_and_b64 s[60:61], s[60:61], s[76:77]
    s_cbranch_scc0 L_polld_56
    s_add_u32 s51, s51, 1
    s_cmp_gt_u32 s51, 200000
    s_cbranch_scc1 L_polld_56
    s_sleep 1
    s_branch L_poll_55
L_polld_56:
    v_mov_b32 v8, v144
    v_mov_b32 v9, v145
    v_mov_b32 v10, v146
    v_mov_b32 v11, v147
    s_nop 0
    v_permlane32_swap_b32 v8, v10
    v_permlane32_swap_b32 v9, v11
    v_add_f32 v8, v8, v10
    v_add_f32 v9, v9, v11
    s_nop 1
    v_permlane16_swap_b32 v8, v9
    v_add_f32 v8, v8, v9
    s_nop 1
    v_add_f32_dpp v9, v8, v8 row_ror:8 row_mask:0xf bank_mask:0xf
    s_mov_b32 exec_lo, 0xff00ff
    s_mov_b32 exec_hi, 0xff00ff
    ds_write_b32 v5, v9 offset:1024
    s_mov_b64 exec, -1
    s_waitcnt lgkmcnt(0)
    s_barrier
    s_cmp_lg_u32 s48, 0
    s_cbranch_scc1 L_fin
    v_lshlrev_b32 v4, 2, v1
    v_add_u32 v5, s53, v4
    s_mov_b32 exec_lo, 0xffffffff
    s_mov_b32 exec_hi, 0x0
    ds_read_b32 v156, v4 offset:1024
    ds_read_b32 v157, v4 offset:1152
    ds_read_b32 v158, v4 offset:1280
    ds_read_b32 v159, v4 offset:1408
    ds_read_b32 v160, v4 offset:1536
    ds_read_b32 v161, v4 offset:1664
    ds_read_b32 v162, v4 offset:1792
    ds_read_b32 v163, v4 offset:1920
    ds_read_b32 v164, v5 offset:7168
    s_waitcnt lgkmcnt(0)
    v_add_f32 v156, v156, v160
    v_add_f32 v157, v157, v161
    v_add_f32 v158, v158, v162
    v_add_f32 v159, v159, v163
    v_add_f32 v156, v156, v158
    v_add_f32 v157, v157, v159
    v_add_f32 v156, v156, v157
    v_cvt_pk_bf16_f32 v156, v156, v156
    v_lshlrev_b32 v156, 16, v156
    v_add_f32 v156, v156, v164
    v_cvt_pk_bf16_f32 v156, v156, v156
    v_lshrrev_b32 v5, 1, v5
    buffer_store_short v156, v5, s[36:39], 0 offen
    s_mov_b64 exec, -1
L_fin:
L_end:
    s_endpgm
.section .rodata,"a"
.p2align 6
.amdhsa_kernel sequential_preLN__compressed_kv_cla__dense_activation_relu__decode_kernel
  .amdhsa_next_free_vgpr 248
  .amdhsa_next_free_sgpr 102
  .amdhsa_accum_offset 248
  .amdhsa_group_segment_fixed_size 0
  .amdhsa_kernarg_size 96
  .amdhsa_user_sgpr_count 2
  .amdhsa_user_sgpr_kernarg_segment_ptr 1
  .amdhsa_system_sgpr_workgroup_id_x 1
.end_amdhsa_kernel
```
